```python
import torch

def _softmax(x, axis=-1):
    return torch.softmax(x, dim=axis)
def _gelu(x):
    return torch.nn.functional.gelu(x, approximate="tanh")
def _silu(x):
    return torch.nn.functional.silu(x)
def _sigmoid(x):
    return torch.sigmoid(x)
def _layernorm(x, axis=-1, eps=1e-5):
    m = x.mean(dim=axis, keepdim=True)
    v = x.var(dim=axis, keepdim=True, unbiased=False)
    return (x - m) / torch.sqrt(v + eps)
def _scatter_add(tgt, idx, src, axis=0):
    return tgt.clone().index_add_(axis, idx, src)
def _segment_sum(src, seg, n):
    out = torch.zeros((n,) + src.shape[1:], dtype=src.dtype)
    return out.index_add_(0, seg, src)
def _pad(x, pw):
    flat = tuple(v for pair in reversed(pw) for v in pair)
    return torch.nn.functional.pad(x, flat)

kernel_name = 'gated_mix__gqa_block_cached__dense_activation_relu__decode'

def setup_inputs():

    _w = (lambda a: (lambda t: t.to(torch.bfloat16) if t.is_floating_point() else t)(torch.as_tensor(a)))
    def _A_setup():
        B, Sq, D = 4, 1, 448
        Hq, Hkv, Sk, Dh = 16, 8, 8192, 256
        assert Hq % Hkv == 0, (Hq, Hkv)
        return {
            "x": _w((lambda *s: torch.randn(*s, dtype=torch.bfloat16) * 0.05)(B, Sq, D)),
            "k_cache": _w((lambda *s: torch.randn(*s, dtype=torch.bfloat16) * 6.4)(B, Hkv, Sk, Dh)),
            "v_cache": _w((lambda *s: torch.randn(*s, dtype=torch.bfloat16) * 1.6)(B, Hkv, Sk, Dh)),
            "wq": _w((lambda *s: torch.randn(*s, dtype=torch.bfloat16) * 6.4)(D, Hq * Dh) * (D ** -0.5)),
            "wo": _w((lambda *s: torch.randn(*s, dtype=torch.bfloat16) * 1.6)(Hq * Dh, D) * ((Hq * Dh) ** -0.5)),
        }
    _A_in = _A_setup()

    def _B_setup():
        B, S, D, Dff = 4, 1, 448, 1792
        return {
            "x": _w((lambda *s: torch.randn(*s, dtype=torch.bfloat16) * 0.05)(B, S, D)),
            "w1": _w((lambda *s: torch.randn(*s, dtype=torch.bfloat16) * 0.05)(D, Dff)),
            "w2": _w((lambda *s: torch.randn(*s, dtype=torch.bfloat16) * 0.05)(Dff, D)),
        }
    _B_in = _B_setup()

    return {
        "A_x": _A_in["x"],
        "A_k_cache": _A_in["k_cache"],
        "A_v_cache": _A_in["v_cache"],
        "A_wq": _A_in["wq"],
        "A_wo": _A_in["wo"],
        "B_x": _B_in["x"],
        "B_w1": _B_in["w1"],
        "B_w2": _B_in["w2"],
        "gate_w": _w((lambda *s: torch.randn(*s, dtype=torch.bfloat16) * 0.05)(448) * 16.0),
    }

def reference(A_x, A_k_cache, A_v_cache, A_wq, A_wo, B_x, B_w1, B_w2, gate_w):
    def _A_ref(x, k_cache, v_cache, wq, wo):
        B, Sq, D = x.shape
        Hq, Dh = 16, 256
        Hkv = k_cache.shape[1]
        rep = Hq // Hkv
        q = (lambda x, *d: x.permute(*d))((x @ wq).reshape(B, Sq, Hq, Dh), 0, 2, 1, 3)
        k = (lambda x, n, axis: torch.repeat_interleave(x, n, dim=axis))(k_cache, rep, axis=1)
        v = (lambda x, n, axis: torch.repeat_interleave(x, n, dim=axis))(v_cache, rep, axis=1)
        scores = torch.einsum("bhqd,bhkd->bhqk", q, k) * (Dh ** -0.5)
        p = _softmax(scores, axis=-1)
        o = torch.einsum("bhqk,bhkd->bhqd", p, v)
        return (lambda x, *d: x.permute(*d))(o, 0, 2, 1, 3).reshape(B, Sq, Hq * Dh) @ wo

    def _B_ref(x, w1, w2):
        h = torch.einsum("bsd,df->bsf", x, w1)
        zero = torch.zeros_like(h)
        h = torch.maximum(h, zero)
        return torch.einsum("bsf,fd->bsd", h, w2)

    x = A_x
    g = _sigmoid((x * gate_w).sum(-1, keepdims=True))
    a = _A_ref(x, A_k_cache, A_v_cache, A_wq, A_wo)
    b = _B_ref(x, B_w1, B_w2)
    return g * a + (1 - g) * b
```

```asm
; @launch grid=(256,1,1) block=(512,1,1) lds=25088
.amdgcn_target "amdgcn-amd-amdhsa--gfx950"
.text
.globl gated_mix__gqa_block_cached__dense_activation_relu__decode_kernel
.p2align 8
.type gated_mix__gqa_block_cached__dense_activation_relu__decode_kernel,@function
gated_mix__gqa_block_cached__dense_activation_relu__decode_kernel:
    s_cmp_ge_u32 s2, 256
    s_cbranch_scc1 L_end
    s_load_dwordx16 s[4:19], s[0:1], 0
    s_load_dwordx8 s[20:27], s[0:1], 64
    v_lshrrev_b32 v1, 6, v0
    v_and_b32 v0, 63, v0
    v_readfirstlane_b32 s28, v1
    s_and_b32 s29, s2, 31
    s_lshr_b32 s30, s2, 5
    s_and_b32 s31, s2, 7
    s_cmp_ge_u32 s28, 4
    s_nop 0
    s_cbranch_scc1 L_helper
    v_and_b32 v5, 15, v0
    v_lshrrev_b32 v6, 4, v0
    v_lshrrev_b32 v7, 3, v5
    v_lshlrev_b32 v1, 9, v7
    v_lshl_add_u32 v1, v6, 7, v1
    v_and_b32 v7, 7, v5
    v_lshl_add_u32 v1, v7, 4, v1
    v_lshlrev_b32 v2, 4, v0
    s_add_u32 s84, s28, 0
    s_add_u32 s85, s28, 4
    s_add_u32 s86, s28, 8
    s_add_u32 s87, s28, 12
    s_add_u32 s88, s28, 16
    s_add_u32 s89, s28, 20
    s_lshl_b32 s73, s29, 22
    s_lshl_b32 s74, s30, 19
    s_add_u32 s73, s73, s74
    s_mov_b32 s38, 0x80000
    s_mov_b32 s39, 0x20000
    s_mov_b32 s42, 0x80000
    s_mov_b32 s43, 0x20000
    s_waitcnt lgkmcnt(0)
    s_add_u32 s36, s6, s73
    s_addc_u32 s37, s7, 0
    s_add_u32 s40, s8, s73
    s_addc_u32 s41, s9, 0
    s_lshl_b32 s70, s28, 12
    buffer_load_dwordx4 v[64:67], v1, s[36:39], s70 offen offset:0 nt
    buffer_load_dwordx4 v[68:71], v1, s[36:39], s70 offen offset:1024 nt
    buffer_load_dwordx4 v[72:75], v1, s[36:39], s70 offen offset:2048 nt
    buffer_load_dwordx4 v[76:79], v1, s[36:39], s70 offen offset:3072 nt
    s_add_u32 s70, s70, 0x4000
    buffer_load_dwordx4 v[80:83], v1, s[36:39], s70 offen offset:0 nt
    buffer_load_dwordx4 v[84:87], v1, s[36:39], s70 offen offset:1024 nt
    buffer_load_dwordx4 v[88:91], v1, s[36:39], s70 offen offset:2048 nt
    buffer_load_dwordx4 v[92:95], v1, s[36:39], s70 offen offset:3072 nt
    s_add_u32 s70, s70, 0x4000
    buffer_load_dwordx4 v[96:99], v1, s[36:39], s70 offen offset:0 nt
    buffer_load_dwordx4 v[100:103], v1, s[36:39], s70 offen offset:1024 nt
    buffer_load_dwordx4 v[104:107], v1, s[36:39], s70 offen offset:2048 nt
    buffer_load_dwordx4 v[108:111], v1, s[36:39], s70 offen offset:3072 nt
    s_add_u32 s70, s70, 0x4000
    s_branch L_stream2
L_helper:
    s_setprio 3
    s_sub_u32 s34, s28, 4
    s_lshr_b32 s35, s2, 3
    v_lshrrev_b32 v3, 1, v0
    v_lshlrev_b32 v3, 13, v3
    v_and_b32 v6, 1, v0
    v_lshl_add_u32 v3, v6, 4, v3
    s_lshl_b32 s73, s31, 10
    s_lshl_b32 s74, s35, 5
    s_add_u32 s72, s73, s74
    v_add_u32 v3, s72, v3
    s_lshl_b32 s75, s34, 20
    s_add_u32 s76, s75, 0x40000
    s_add_u32 s77, s75, 0x80000
    s_add_u32 s78, s75, 0xc0000
    v_and_b32 v1, 15, v0
    v_lshrrev_b32 v2, 4, v0
    v_and_b32 v4, 3, v1
    v_mul_u32_u24 v4, 0x380, v4
    v_lshl_add_u32 v4, v2, 4, v4
    s_lshl_b32 s73, s34, 8
    v_add_u32 v4, s73, v4
    s_mov_b32 s42, 0x380000
    s_mov_b32 s43, 0x20000
    s_waitcnt lgkmcnt(0)
    s_mov_b32 s40, s10
    s_mov_b32 s41, s11
    buffer_load_dwordx4 v[16:19], v3, s[40:43], s75 offen
    buffer_load_dwordx4 v[20:23], v3, s[40:43], s76 offen
    buffer_load_dwordx4 v[24:27], v3, s[40:43], s77 offen
    buffer_load_dwordx4 v[28:31], v3, s[40:43], s78 offen
    s_mov_b32 s36, s4
    s_mov_b32 s37, s5
    s_mov_b32 s38, 0xe00
    s_mov_b32 s39, 0x20000
    buffer_load_dwordx4 v[48:51], v4, s[36:39], 0 offen offset:0
    buffer_load_dwordx4 v[52:55], v4, s[36:39], 0 offen offset:64
    buffer_load_dwordx4 v[56:59], v4, s[36:39], 0 offen offset:128
    buffer_load_dwordx4 v[60:63], v4, s[36:39], 0 offen offset:192
    s_mov_b32 s44, s26
    s_mov_b32 s45, s27
    s_mov_b32 s46, 0x300000
    s_mov_b32 s47, 0x20000
    s_bfe_u32 s32, s2, 0x20003
    s_lshl_b32 s33, s31, 3
    s_add_u32 s33, s33, s30
    s_cmp_lg_u32 s34, 3
    s_cbranch_scc1 L_nozero
    v_mov_b32 v12, 0
    v_mov_b32 v13, 0
    v_mov_b32 v14, 0
    v_mov_b32 v15, 0
    v_lshlrev_b32 v9, 4, v0
    s_lshl_b32 s73, s2, 11
    s_add_u32 s73, s73, 0x100000
    buffer_store_dwordx4 v[12:15], v9, s[44:47], s73 offen sc1
    buffer_store_dwordx4 v[12:15], v9, s[44:47], s73 offen offset:1024 sc1
    s_cmp_ge_u32 s33, 56
    s_nop 0
    s_cbranch_scc1 L_noz2
    s_lshl_b32 s73, s32, 6
    s_add_u32 s73, s73, s33
    s_lshl_b32 s73, s73, 12
    s_add_u32 s74, s73, 0x200000
    buffer_store_dwordx4 v[12:15], v9, s[44:47], s74 offen offset:0 sc1
    buffer_store_dwordx4 v[12:15], v9, s[44:47], s74 offen offset:1024 sc1
    buffer_store_dwordx4 v[12:15], v9, s[44:47], s74 offen offset:2048 sc1
    buffer_store_dwordx4 v[12:15], v9, s[44:47], s74 offen offset:3072 sc1
    s_nop 1
L_noz2:
    s_lshl_b32 s73, s2, 6
    s_add_u32 s73, s73, 0x180000
    s_mov_b64 exec, 0xf
    buffer_store_dwordx4 v[12:15], v9, s[44:47], s73 offen sc1
    s_lshl_b32 s73, s2, 7
    s_add_u32 s73, s73, 0x40000
    s_mov_b64 exec, 1
    buffer_store_dwordx4 v[12:15], v9, s[44:47], s73 offen sc1
    ds_write_b64 v9, v[12:13] offset:2192
    v_mov_b32 v10, 24
    v_mov_b32 v11, 0
    ds_write_b64 v9, v[10:11] offset:2200
    ds_write_b32 v9, v11 offset:2208
    ds_write_b32 v9, v11 offset:2212
    v_mov_b32 v10, 0xff800000
    v_mov_b32 v11, 0xff800000
    ds_write_b64 v9, v[10:11] offset:2216
    s_mov_b64 exec, -1
    s_nop 0
L_nozero:
    s_lshl_b32 s73, s34, 11
    v_lshlrev_b32 v6, 4, v0
    v_add_u32 v6, s73, v6
    v_lshrrev_b32 v7, 2, v1
    v_lshl_add_u32 v7, v2, 3, v7
    v_lshlrev_b32 v7, 5, v7
    v_and_b32 v8, 3, v1
    v_lshl_add_u32 v7, v8, 3, v7
    v_add_u32 v8, s73, v7
    s_lshl_b32 s73, s34, 8
    v_lshlrev_b32 v9, 4, v1
    v_add_u32 v9, s73, v9
    s_mov_b32 s56, 0x05040100
    s_mov_b32 s57, 0x07060302
    s_mov_b32 s58, 0x3db8aa3b
    s_mov_b32 s52, s24
    s_mov_b32 s53, s25
    s_mov_b32 s54, 0x100
    s_mov_b32 s55, 0x20000
    s_waitcnt vmcnt(0)
    ds_write_b128 v6, v[16:19] offset:4608
    ds_write_b128 v6, v[20:23] offset:5632
    s_waitcnt lgkmcnt(0)
    ds_read_b64_tr_b16 v[32:33], v8 offset:4608
    ds_read_b64_tr_b16 v[34:35], v8 offset:4736
    ds_read_b64_tr_b16 v[36:37], v8 offset:5632
    ds_read_b64_tr_b16 v[38:39], v8 offset:5760
    s_waitcnt lgkmcnt(0)
    v_mfma_f32_16x16x32_bf16 v[12:15], v[48:51], v[32:35], 0
    v_mfma_f32_16x16x32_bf16 v[12:15], v[52:55], v[36:39], v[12:15]
    ds_write_b128 v6, v[24:27] offset:4608
    ds_write_b128 v6, v[28:31] offset:5632
    s_waitcnt lgkmcnt(0)
    ds_read_b64_tr_b16 v[40:41], v8 offset:4608
    ds_read_b64_tr_b16 v[42:43], v8 offset:4736
    ds_read_b64_tr_b16 v[44:45], v8 offset:5632
    ds_read_b64_tr_b16 v[46:47], v8 offset:5760
    s_waitcnt lgkmcnt(0)
    v_mfma_f32_16x16x32_bf16 v[12:15], v[56:59], v[40:43], v[12:15]
    v_mfma_f32_16x16x32_bf16 v[12:15], v[60:63], v[44:47], v[12:15]
    s_mov_b64 exec, 0xffff
    s_nop 6
    ds_write_b128 v9, v[12:15] offset:1024
    s_mov_b64 exec, -1
    s_waitcnt lgkmcnt(0)
    s_barrier
    s_cmp_eq_u32 s34, 0
    s_cbranch_scc1 L_qcons
    s_cmp_lg_u32 s34, 2
    s_cbranch_scc1 L_hB
    v_lshlrev_b32 v6, 2, v0
    ds_read_b32 v8, v6 offset:1024
    ds_read_b32 v9, v6 offset:1280
    ds_read_b32 v10, v6 offset:1536
    ds_read_b32 v11, v6 offset:1792
    s_memrealtime s[74:75]
    v_and_b32 v7, 3, v0
    v_lshlrev_b32 v7, 15, v7
    v_lshrrev_b32 v12, 2, v0
    v_lshl_add_u32 v7, v12, 3, v7
    s_lshl_b32 s73, s72, 2
    s_waitcnt lgkmcnt(0)
    s_lshl_b64 s[74:75], s[74:75], 16
    v_add_f32 v8, v8, v9
    v_add_f32 v10, v10, v11
    v_add_f32 v8, v8, v10
    v_cvt_pk_bf16_f32 v8, v8, v8
    v_and_b32 v8, 0xffff, v8
    v_or_b32 v8, s74, v8
    v_mov_b32 v9, s75
    buffer_store_dwordx2 v[8:9], v7, s[44:47], s73 offen offset:0 sc1
    s_lshl_b32 s73, s31, 5
    v_mov_b32 v11, s73
    v_mov_b32 v10, 1
    v_mov_b32 v12, 0
    v_mov_b32 v13, 1
    ds_write_b32 v12, v13 offset:2208
    v_lshlrev_b32 v14, 10, v0
    s_lshl_b32 s76, s31, 7
    s_add_u32 s76, s76, 0x40000
    s_waitcnt vmcnt(0)
    s_mov_b64 exec, 1
    buffer_atomic_add v10, v11, s[52:55], 0 offen sc0 sc1
    s_mov_b64 exec, -1
    s_waitcnt vmcnt(0)
    v_readfirstlane_b32 s75, v10
    s_nop 0
    s_and_b32 s75, s75, 31
    s_cmp_lg_u32 s75, 31
    s_nop 1
    s_cbranch_scc1 L_hB
    s_mov_b32 s74, -1
    s_mov_b32 s75, 0
    s_mov_b64 exec, s[74:75]
    buffer_store_dword v13, v14, s[44:47], s76 offen sc1
    s_mov_b64 exec, 1
    v_mov_b32 v10, 1
    buffer_atomic_add v10, v12, s[52:55], 0 offen offset:16 sc0 sc1
    s_mov_b64 exec, -1
    v_lshlrev_b32 v14, 7, v0
    s_waitcnt vmcnt(0)
    v_readfirstlane_b32 s75, v10
    s_nop 0
    s_and_b32 s75, s75, 7
    s_cmp_lg_u32 s75, 7
    s_nop 1
    s_cbranch_scc1 L_hB
    s_mov_b32 s76, 0x40000
    buffer_store_dword v13, v14, s[44:47], s76 offen offset:4 sc1
    s_mov_b32 s76, 0x42000
    buffer_store_dword v13, v14, s[44:47], s76 offen offset:4 sc1
    s_mov_b32 s76, 0x44000
    buffer_store_dword v13, v14, s[44:47], s76 offen offset:4 sc1
    s_mov_b32 s76, 0x46000
    buffer_store_dword v13, v14, s[44:47], s76 offen offset:4 sc1
    s_branch L_hB
L_qcons:
    s_lshl_b32 s73, s32, 15
    s_lshl_b32 s74, s31, 12
    s_add_u32 s73, s73, s74
    s_lshl_b32 s76, s2, 7
    s_add_u32 s76, s76, 0x40000
    v_lshlrev_b32 v6, 4, v0
    v_mov_b32 v12, 0
    s_mov_b32 s77, 0
    s_mov_b32 s78, 0
    buffer_load_dwordx4 v[16:19], v6, s[44:47], s73 offen offset:0 sc1
    buffer_load_dwordx4 v[20:23], v6, s[44:47], s73 offen offset:1024 sc1
    buffer_load_dwordx4 v[24:27], v6, s[44:47], s73 offen offset:2048 sc1
    buffer_load_dwordx4 v[28:31], v6, s[44:47], s73 offen offset:3072 sc1
    buffer_load_dword v32, v12, s[44:47], s76 offen sc1
    s_sleep 8
    buffer_load_dwordx4 v[36:39], v6, s[44:47], s73 offen offset:0 sc1
    buffer_load_dwordx4 v[40:43], v6, s[44:47], s73 offen offset:1024 sc1
    buffer_load_dwordx4 v[44:47], v6, s[44:47], s73 offen offset:2048 sc1
    buffer_load_dwordx4 v[48:51], v6, s[44:47], s73 offen offset:3072 sc1
    buffer_load_dword v52, v12, s[44:47], s76 offen sc1
    s_sleep 8
L_qpoll:
    buffer_load_dwordx4 v[56:59], v6, s[44:47], s73 offen offset:0 sc1
    buffer_load_dwordx4 v[60:63], v6, s[44:47], s73 offen offset:1024 sc1
    buffer_load_dwordx4 v[64:67], v6, s[44:47], s73 offen offset:2048 sc1
    buffer_load_dwordx4 v[68:71], v6, s[44:47], s73 offen offset:3072 sc1
    buffer_load_dword v72, v12, s[44:47], s76 offen sc1
    s_memrealtime s[62:63]
    s_add_u32 s78, s78, 1
    s_waitcnt lgkmcnt(0)
    s_sub_u32 s64, s62, 2000
    s_subb_u32 s65, s63, 0
    s_add_u32 s66, s62, 300
    s_addc_u32 s67, s63, 0
    s_lshl_b64 s[64:65], s[64:65], 16
    s_lshl_b64 s[66:67], s[66:67], 16
    s_waitcnt vmcnt(10)
    s_cmp_ge_u32 s77, 3
    s_cbranch_scc1 L_qgot0
    s_cmp_ge_u32 s78, 1048576
    s_cbranch_scc1 L_qgot0
    v_readfirstlane_b32 s79, v32
    s_nop 0
    s_or_b32 s79, s79, s77
    s_cmp_lg_u32 s79, 0
    s_addc_u32 s77, s77, 0
    s_mov_b64 s[68:69], exec
    v_cmp_le_u64 vcc, s[64:65], v[16:17]
    s_nop 0
    s_and_b64 s[68:69], s[68:69], vcc
    v_cmp_gt_u64 vcc, s[66:67], v[16:17]
    s_nop 0
    s_and_b64 s[68:69], s[68:69], vcc
    v_cmp_le_u64 vcc, s[64:65], v[18:19]
    s_nop 0
    s_and_b64 s[68:69], s[68:69], vcc
    v_cmp_gt_u64 vcc, s[66:67], v[18:19]
    s_nop 0
    s_and_b64 s[68:69], s[68:69], vcc
    v_cmp_le_u64 vcc, s[64:65], v[20:21]
    s_nop 0
    s_and_b64 s[68:69], s[68:69], vcc
    v_cmp_gt_u64 vcc, s[66:67], v[20:21]
    s_nop 0
    s_and_b64 s[68:69], s[68:69], vcc
    v_cmp_le_u64 vcc, s[64:65], v[22:23]
    s_nop 0
    s_and_b64 s[68:69], s[68:69], vcc
    v_cmp_gt_u64 vcc, s[66:67], v[22:23]
    s_nop 0
    s_and_b64 s[68:69], s[68:69], vcc
    v_cmp_le_u64 vcc, s[64:65], v[24:25]
    s_nop 0
    s_and_b64 s[68:69], s[68:69], vcc
    v_cmp_gt_u64 vcc, s[66:67], v[24:25]
    s_nop 0
    s_and_b64 s[68:69], s[68:69], vcc
    v_cmp_le_u64 vcc, s[64:65], v[26:27]
    s_nop 0
    s_and_b64 s[68:69], s[68:69], vcc
    v_cmp_gt_u64 vcc, s[66:67], v[26:27]
    s_nop 0
    s_and_b64 s[68:69], s[68:69], vcc
    v_cmp_le_u64 vcc, s[64:65], v[28:29]
    s_nop 0
    s_and_b64 s[68:69], s[68:69], vcc
    v_cmp_gt_u64 vcc, s[66:67], v[28:29]
    s_nop 0
    s_and_b64 s[68:69], s[68:69], vcc
    v_cmp_le_u64 vcc, s[64:65], v[30:31]
    s_nop 0
    s_and_b64 s[68:69], s[68:69], vcc
    v_cmp_gt_u64 vcc, s[66:67], v[30:31]
    s_nop 0
    s_and_b64 s[68:69], s[68:69], vcc
    s_cmp_eq_u64 s[68:69], exec
    s_nop 1
    s_cbranch_scc1 L_qgot0
    s_sleep 8
    buffer_load_dwordx4 v[16:19], v6, s[44:47], s73 offen offset:0 sc1
    buffer_load_dwordx4 v[20:23], v6, s[44:47], s73 offen offset:1024 sc1
    buffer_load_dwordx4 v[24:27], v6, s[44:47], s73 offen offset:2048 sc1
    buffer_load_dwordx4 v[28:31], v6, s[44:47], s73 offen offset:3072 sc1
    buffer_load_dword v32, v12, s[44:47], s76 offen sc1
    s_memrealtime s[62:63]
    s_add_u32 s78, s78, 1
    s_waitcnt lgkmcnt(0)
    s_sub_u32 s64, s62, 2000
    s_subb_u32 s65, s63, 0
    s_add_u32 s66, s62, 300
    s_addc_u32 s67, s63, 0
    s_lshl_b64 s[64:65], s[64:65], 16
    s_lshl_b64 s[66:67], s[66:67], 16
    s_waitcnt vmcnt(10)
    s_cmp_ge_u32 s77, 3
    s_cbranch_scc1 L_qgot1
    s_cmp_ge_u32 s78, 1048576
    s_cbranch_scc1 L_qgot1
    v_readfirstlane_b32 s79, v52
    s_nop 0
    s_or_b32 s79, s79, s77
    s_cmp_lg_u32 s79, 0
    s_addc_u32 s77, s77, 0
    s_mov_b64 s[68:69], exec
    v_cmp_le_u64 vcc, s[64:65], v[36:37]
    s_nop 0
    s_and_b64 s[68:69], s[68:69], vcc
    v_cmp_gt_u64 vcc, s[66:67], v[36:37]
    s_nop 0
    s_and_b64 s[68:69], s[68:69], vcc
    v_cmp_le_u64 vcc, s[64:65], v[38:39]
    s_nop 0
    s_and_b64 s[68:69], s[68:69], vcc
    v_cmp_gt_u64 vcc, s[66:67], v[38:39]
    s_nop 0
    s_and_b64 s[68:69], s[68:69], vcc
    v_cmp_le_u64 vcc, s[64:65], v[40:41]
    s_nop 0
    s_and_b64 s[68:69], s[68:69], vcc
    v_cmp_gt_u64 vcc, s[66:67], v[40:41]
    s_nop 0
    s_and_b64 s[68:69], s[68:69], vcc
    v_cmp_le_u64 vcc, s[64:65], v[42:43]
    s_nop 0
    s_and_b64 s[68:69], s[68:69], vcc
    v_cmp_gt_u64 vcc, s[66:67], v[42:43]
    s_nop 0
    s_and_b64 s[68:69], s[68:69], vcc
    v_cmp_le_u64 vcc, s[64:65], v[44:45]
    s_nop 0
    s_and_b64 s[68:69], s[68:69], vcc
    v_cmp_gt_u64 vcc, s[66:67], v[44:45]
    s_nop 0
    s_and_b64 s[68:69], s[68:69], vcc
    v_cmp_le_u64 vcc, s[64:65], v[46:47]
    s_nop 0
    s_and_b64 s[68:69], s[68:69], vcc
    v_cmp_gt_u64 vcc, s[66:67], v[46:47]
    s_nop 0
    s_and_b64 s[68:69], s[68:69], vcc
    v_cmp_le_u64 vcc, s[64:65], v[48:49]
    s_nop 0
    s_and_b64 s[68:69], s[68:69], vcc
    v_cmp_gt_u64 vcc, s[66:67], v[48:49]
    s_nop 0
    s_and_b64 s[68:69], s[68:69], vcc
    v_cmp_le_u64 vcc, s[64:65], v[50:51]
    s_nop 0
    s_and_b64 s[68:69], s[68:69], vcc
    v_cmp_gt_u64 vcc, s[66:67], v[50:51]
    s_nop 0
    s_and_b64 s[68:69], s[68:69], vcc
    s_cmp_eq_u64 s[68:69], exec
    s_nop 1
    s_cbranch_scc1 L_qgot1
    s_sleep 8
    buffer_load_dwordx4 v[36:39], v6, s[44:47], s73 offen offset:0 sc1
    buffer_load_dwordx4 v[40:43], v6, s[44:47], s73 offen offset:1024 sc1
    buffer_load_dwordx4 v[44:47], v6, s[44:47], s73 offen offset:2048 sc1
    buffer_load_dwordx4 v[48:51], v6, s[44:47], s73 offen offset:3072 sc1
    buffer_load_dword v52, v12, s[44:47], s76 offen sc1
    s_memrealtime s[62:63]
    s_add_u32 s78, s78, 1
    s_waitcnt lgkmcnt(0)
    s_sub_u32 s64, s62, 2000
    s_subb_u32 s65, s63, 0
    s_add_u32 s66, s62, 300
    s_addc_u32 s67, s63, 0
    s_lshl_b64 s[64:65], s[64:65], 16
    s_lshl_b64 s[66:67], s[66:67], 16
    s_waitcnt vmcnt(10)
    s_cmp_ge_u32 s77, 3
    s_cbranch_scc1 L_qgot2
    s_cmp_ge_u32 s78, 1048576
    s_cbranch_scc1 L_qgot2
    v_readfirstlane_b32 s79, v72
    s_nop 0
    s_or_b32 s79, s79, s77
    s_cmp_lg_u32 s79, 0
    s_addc_u32 s77, s77, 0
    s_mov_b64 s[68:69], exec
    v_cmp_le_u64 vcc, s[64:65], v[56:57]
    s_nop 0
    s_and_b64 s[68:69], s[68:69], vcc
    v_cmp_gt_u64 vcc, s[66:67], v[56:57]
    s_nop 0
    s_and_b64 s[68:69], s[68:69], vcc
    v_cmp_le_u64 vcc, s[64:65], v[58:59]
    s_nop 0
    s_and_b64 s[68:69], s[68:69], vcc
    v_cmp_gt_u64 vcc, s[66:67], v[58:59]
    s_nop 0
    s_and_b64 s[68:69], s[68:69], vcc
    v_cmp_le_u64 vcc, s[64:65], v[60:61]
    s_nop 0
    s_and_b64 s[68:69], s[68:69], vcc
    v_cmp_gt_u64 vcc, s[66:67], v[60:61]
    s_nop 0
    s_and_b64 s[68:69], s[68:69], vcc
    v_cmp_le_u64 vcc, s[64:65], v[62:63]
    s_nop 0
    s_and_b64 s[68:69], s[68:69], vcc
    v_cmp_gt_u64 vcc, s[66:67], v[62:63]
    s_nop 0
    s_and_b64 s[68:69], s[68:69], vcc
    v_cmp_le_u64 vcc, s[64:65], v[64:65]
    s_nop 0
    s_and_b64 s[68:69], s[68:69], vcc
    v_cmp_gt_u64 vcc, s[66:67], v[64:65]
    s_nop 0
    s_and_b64 s[68:69], s[68:69], vcc
    v_cmp_le_u64 vcc, s[64:65], v[66:67]
    s_nop 0
    s_and_b64 s[68:69], s[68:69], vcc
    v_cmp_gt_u64 vcc, s[66:67], v[66:67]
    s_nop 0
    s_and_b64 s[68:69], s[68:69], vcc
    v_cmp_le_u64 vcc, s[64:65], v[68:69]
    s_nop 0
    s_and_b64 s[68:69], s[68:69], vcc
    v_cmp_gt_u64 vcc, s[66:67], v[68:69]
    s_nop 0
    s_and_b64 s[68:69], s[68:69], vcc
    v_cmp_le_u64 vcc, s[64:65], v[70:71]
    s_nop 0
    s_and_b64 s[68:69], s[68:69], vcc
    v_cmp_gt_u64 vcc, s[66:67], v[70:71]
    s_nop 0
    s_and_b64 s[68:69], s[68:69], vcc
    s_cmp_eq_u64 s[68:69], exec
    s_nop 1
    s_cbranch_scc1 L_qgot2
    s_sleep 8
    s_branch L_qpoll
L_qgot0:
    v_perm_b32 v8, v18, v16, s56
    v_perm_b32 v9, v22, v20, s56
    v_perm_b32 v10, v26, v24, s56
    v_perm_b32 v11, v30, v28, s56
    s_nop 2
    s_branch L_qgot
L_qgot1:
    v_perm_b32 v8, v38, v36, s56
    v_perm_b32 v9, v42, v40, s56
    v_perm_b32 v10, v46, v44, s56
    v_perm_b32 v11, v50, v48, s56
    s_nop 2
    s_branch L_qgot
L_qgot2:
    v_perm_b32 v8, v58, v56, s56
    v_perm_b32 v9, v62, v60, s56
    v_perm_b32 v10, v66, v64, s56
    v_perm_b32 v11, v70, v68, s56
    s_nop 2
L_qgot:
    v_lshlrev_b32 v6, 2, v0
    ds_write_b32 v6, v8 offset:0
    ds_write_b32 v6, v9 offset:256
    ds_write_b32 v6, v10 offset:512
    ds_write_b32 v6, v11 offset:768
    v_mov_b32 v13, 1
    s_waitcnt lgkmcnt(0)
    ds_write_b32 v12, v13 offset:2204
    s_waitcnt vmcnt(0)
    s_branch L_hB2
L_hB:
    v_mov_b32 v12, 0
    s_mov_b32 s74, 0
    s_nop 1
L_lw1:
    ds_read_b32 v13, v12 offset:2204
    s_add_u32 s74, s74, 1
    s_waitcnt lgkmcnt(0)
    v_readfirstlane_b32 s75, v13
    s_cmp_ge_u32 s74, 8388608
    s_nop 3
    s_cbranch_scc1 L_lw1_d
    s_cmp_lg_u32 s75, 0
    s_cbranch_scc1 L_lw1_d
    s_sleep 4
    s_branch L_lw1
L_lw1_d:
L_hB2:
    s_branch L_hrest
L_stream2:
    v_mov_b32 v60, 0
    s_mov_b32 s71, 0
    s_barrier
    s_cmp_lg_u32 s71, 0
    s_cbranch_scc1 L_np12
    ds_read_b32 v61, v60 offset:2208
    s_waitcnt vmcnt(8) lgkmcnt(0)
    v_readfirstlane_b32 s71, v61
    s_nop 4
L_np12:
    buffer_load_dwordx4 v[112:115], v1, s[36:39], s70 offen offset:0 nt
    buffer_load_dwordx4 v[116:119], v1, s[36:39], s70 offen offset:1024 nt
    buffer_load_dwordx4 v[120:123], v1, s[36:39], s70 offen offset:2048 nt
    buffer_load_dwordx4 v[124:127], v1, s[36:39], s70 offen offset:3072 nt
    s_add_u32 s70, s70, 0x4000
    s_cmp_lg_u32 s71, 0
    s_cbranch_scc1 L_np16
    ds_read_b32 v61, v60 offset:2208
    s_waitcnt vmcnt(8) lgkmcnt(0)
    v_readfirstlane_b32 s71, v61
    s_nop 4
L_np16:
    buffer_load_dwordx4 v[128:131], v1, s[36:39], s70 offen offset:0 nt
    buffer_load_dwordx4 v[132:135], v1, s[36:39], s70 offen offset:1024 nt
    buffer_load_dwordx4 v[136:139], v1, s[36:39], s70 offen offset:2048 nt
    buffer_load_dwordx4 v[140:143], v1, s[36:39], s70 offen offset:3072 nt
    s_add_u32 s70, s70, 0x4000
    s_cmp_lg_u32 s71, 0
    s_cbranch_scc1 L_np20
    ds_read_b32 v61, v60 offset:2208
    s_waitcnt vmcnt(8) lgkmcnt(0)
    v_readfirstlane_b32 s71, v61
    s_nop 4
L_np20:
    buffer_load_dwordx4 v[144:147], v1, s[36:39], s70 offen offset:0 nt
    buffer_load_dwordx4 v[148:151], v1, s[36:39], s70 offen offset:1024 nt
    buffer_load_dwordx4 v[152:155], v1, s[36:39], s70 offen offset:2048 nt
    buffer_load_dwordx4 v[156:159], v1, s[36:39], s70 offen offset:3072 nt
    s_add_u32 s70, s70, 0x4000
    s_cmp_lg_u32 s71, 0
    s_cbranch_scc1 L_np24
    ds_read_b32 v61, v60 offset:2208
    s_waitcnt vmcnt(8) lgkmcnt(0)
    v_readfirstlane_b32 s71, v61
    s_nop 4
L_np24:
    buffer_load_dwordx4 v[160:163], v1, s[36:39], s70 offen offset:0 nt
    buffer_load_dwordx4 v[164:167], v1, s[36:39], s70 offen offset:1024 nt
    buffer_load_dwordx4 v[168:171], v1, s[36:39], s70 offen offset:2048 nt
    buffer_load_dwordx4 v[172:175], v1, s[36:39], s70 offen offset:3072 nt
    s_add_u32 s70, s70, 0x4000
    s_cmp_lg_u32 s71, 0
    s_cbranch_scc1 L_np28
    ds_read_b32 v61, v60 offset:2208
    s_waitcnt vmcnt(8) lgkmcnt(0)
    v_readfirstlane_b32 s71, v61
    s_nop 4
L_np28:
    buffer_load_dwordx4 v[176:179], v1, s[36:39], s70 offen offset:0 nt
    buffer_load_dwordx4 v[180:183], v1, s[36:39], s70 offen offset:1024 nt
    buffer_load_dwordx4 v[184:187], v1, s[36:39], s70 offen offset:2048 nt
    buffer_load_dwordx4 v[188:191], v1, s[36:39], s70 offen offset:3072 nt
    s_add_u32 s70, s70, 0x4000
    s_cmp_lg_u32 s71, 0
    s_cbranch_scc1 L_np32
    ds_read_b32 v61, v60 offset:2208
    s_waitcnt vmcnt(8) lgkmcnt(0)
    v_readfirstlane_b32 s71, v61
    s_nop 4
L_np32:
    buffer_load_dwordx4 v[192:195], v1, s[36:39], s70 offen offset:0 nt
    buffer_load_dwordx4 v[196:199], v1, s[36:39], s70 offen offset:1024 nt
    buffer_load_dwordx4 v[200:203], v1, s[36:39], s70 offen offset:2048 nt
    buffer_load_dwordx4 v[204:207], v1, s[36:39], s70 offen offset:3072 nt
    s_add_u32 s70, s70, 0x4000
    s_cmp_lg_u32 s71, 0
    s_cbranch_scc1 L_np36
    ds_read_b32 v61, v60 offset:2208
    s_waitcnt vmcnt(8) lgkmcnt(0)
    v_readfirstlane_b32 s71, v61
    s_nop 4
L_np36:
    buffer_load_dwordx4 v[208:211], v1, s[36:39], s70 offen offset:0 nt
    buffer_load_dwordx4 v[212:215], v1, s[36:39], s70 offen offset:1024 nt
    buffer_load_dwordx4 v[216:219], v1, s[36:39], s70 offen offset:2048 nt
    buffer_load_dwordx4 v[220:223], v1, s[36:39], s70 offen offset:3072 nt
    s_add_u32 s70, s70, 0x4000
    s_cmp_lg_u32 s71, 0
    s_cbranch_scc1 L_np40
    ds_read_b32 v61, v60 offset:2208
    s_waitcnt vmcnt(8) lgkmcnt(0)
    v_readfirstlane_b32 s71, v61
    s_nop 4
L_np40:
    buffer_load_dwordx4 v[224:227], v1, s[36:39], s70 offen offset:0 nt
    buffer_load_dwordx4 v[228:231], v1, s[36:39], s70 offen offset:1024 nt
    buffer_load_dwordx4 v[232:235], v1, s[36:39], s70 offen offset:2048 nt
    buffer_load_dwordx4 v[236:239], v1, s[36:39], s70 offen offset:3072 nt
    s_add_u32 s70, s70, 0x4000
    s_cmp_lg_u32 s71, 0
    s_cbranch_scc1 L_np44
    ds_read_b32 v61, v60 offset:2208
    s_waitcnt vmcnt(8) lgkmcnt(0)
    v_readfirstlane_b32 s71, v61
    s_nop 4
L_np44:
    buffer_load_dwordx4 v[240:243], v1, s[36:39], s70 offen offset:0 nt
    buffer_load_dwordx4 v[244:247], v1, s[36:39], s70 offen offset:1024 nt
    buffer_load_dwordx4 v[248:251], v1, s[36:39], s70 offen offset:2048 nt
    buffer_load_dwordx4 v[252:255], v1, s[36:39], s70 offen offset:3072 nt
    s_add_u32 s70, s70, 0x4000
    s_mov_b32 s56, 0x05040100
    s_mov_b32 s57, 0x07060302
    s_mov_b32 s58, 0x3db8aa3b
    s_mov_b32 s59, 0xbdb8aa3b
    s_mov_b32 s44, s26
    s_mov_b32 s45, s27
    s_mov_b32 s46, 0x300000
    s_mov_b32 s47, 0x20000
    s_mov_b32 s60, 0xff0000ff
    s_mov_b32 s61, 0xff0000ff
    s_mov_b32 s62, 0x220011
    s_mov_b32 s63, 0x220011
    s_mov_b32 s64, 0x880044
    s_mov_b32 s65, 0x880044
    s_mov_b32 s66, 0x22001100
    s_mov_b32 s67, 0x22001100
    s_mov_b32 s68, 0x88004400
    s_mov_b32 s69, 0x88004400
    v_and_b32 v7, 3, v5
    v_lshl_add_u32 v7, v6, 3, v7
    v_bfe_u32 v24, v5, 2, 1
    v_lshlrev_b32 v24, 9, v24
    v_lshl_add_u32 v24, v7, 4, v24
    v_lshrrev_b32 v25, 3, v5
    v_lshl_add_u32 v26, v25, 6, v24
    v_xor_b32 v25, 1, v25
    v_lshl_add_u32 v27, v25, 6, v24
    v_mov_b32 v8, 0
    v_mov_b32 v9, 0
    v_mov_b32 v10, 0
    v_mov_b32 v11, 0
    v_mov_b32 v12, 0
    v_mov_b32 v13, 0
    v_mov_b32 v14, 0
    v_mov_b32 v15, 0
    v_mov_b32 v3, 0xff800000
    v_mov_b32 v4, 0
    s_mov_b32 s72, 0
    s_nop 1
L_lw2:
    ds_read_b32 v61, v60 offset:2204
    s_add_u32 s72, s72, 1
    s_waitcnt lgkmcnt(0)
    v_readfirstlane_b32 s71, v61
    s_cmp_ge_u32 s72, 8388608
    s_nop 3
    s_cbranch_scc1 L_lw2_d
    s_cmp_lg_u32 s71, 0
    s_cbranch_scc0 L_lw2
L_lw2_d:
    ds_read_b128 v[16:19], v26 offset:0
    ds_read_b128 v[20:23], v27 offset:0
    v_mov_b32 v61, 1
    v_bfe_u32 v5, v0, 2, 1
    v_lshlrev_b32 v5, 5, v5
    v_lshrrev_b32 v28, 5, v0
    v_lshl_add_u32 v5, v28, 4, v5
    v_bfe_u32 v28, v0, 3, 1
    v_lshl_add_u32 v7, v28, 3, v5
    s_mov_b32 s76, 0x1111
    s_mov_b32 s77, 0x1111
    s_mov_b32 s72, 0
    s_waitcnt lgkmcnt(0)
L_loop:
    s_cmp_ge_u32 s84, 128
    s_cbranch_scc1 L_sdone
    s_and_b32 s75, s84, 63
    s_lshl_b32 s75, s75, 6
    s_cmp_ge_u32 s84, 64
    s_cbranch_scc1 L_V0
    s_mov_b64 exec, 1
    ds_add_rtn_u32 v62, v60, v61 offset:2200
    s_mov_b64 exec, -1
    s_waitcnt vmcnt(46)
    v_mfma_f32_16x16x32_bf16 v[24:27], v[64:67], v[16:19], 0
    v_mfma_f32_16x16x32_bf16 v[28:31], v[68:71], v[20:23], 0
    s_waitcnt vmcnt(44)
    v_mfma_f32_16x16x32_bf16 v[32:35], v[72:75], v[16:19], 0
    v_mfma_f32_16x16x32_bf16 v[36:39], v[76:79], v[20:23], 0
    s_nop 4
    v_cndmask_b32_e64 v24, v28, v24, s[60:61]
    s_nop 1
    v_cndmask_b32_e64 v32, v36, v32, s[60:61]
    v_cndmask_b32_e64 v25, v29, v25, s[60:61]
    v_cndmask_b32_e64 v33, v37, v33, s[60:61]
    v_cndmask_b32_e64 v26, v30, v26, s[60:61]
    v_cndmask_b32_e64 v34, v38, v34, s[60:61]
    v_cndmask_b32_e64 v27, v31, v27, s[60:61]
    v_cndmask_b32_e64 v35, v39, v35, s[60:61]
    v_mov_b32_dpp v40, v24 quad_perm:[0,0,0,0] row_mask:0xf bank_mask:0xf
    v_mov_b32_dpp v41, v32 quad_perm:[0,0,0,0] row_mask:0xf bank_mask:0xf
    s_nop 0
    v_add_f32_dpp v40, v25, v40 quad_perm:[1,1,1,1] row_mask:0xf bank_mask:0xf
    v_add_f32_dpp v41, v33, v41 quad_perm:[1,1,1,1] row_mask:0xf bank_mask:0xf
    s_nop 0
    v_add_f32_dpp v40, v26, v40 quad_perm:[2,2,2,2] row_mask:0xf bank_mask:0xf
    v_add_f32_dpp v41, v34, v41 quad_perm:[2,2,2,2] row_mask:0xf bank_mask:0xf
    s_nop 0
    v_add_f32_dpp v40, v27, v40 quad_perm:[3,3,3,3] row_mask:0xf bank_mask:0xf
    v_add_f32_dpp v41, v35, v41 quad_perm:[3,3,3,3] row_mask:0xf bank_mask:0xf
    s_nop 0
    v_mov_b32_dpp v40, v40 row_ror:8 row_mask:0xa bank_mask:0xf
    v_mov_b32_dpp v41, v41 row_ror:8 row_mask:0xa bank_mask:0xf
    v_mov_b32 v56, v40
    v_mov_b32 v57, v41
    s_nop 0
    v_permlane16_swap_b32 v40, v56
    v_permlane16_swap_b32 v41, v57
    v_add_f32 v40, v40, v56
    v_add_f32 v41, v41, v57
    v_cvt_pk_bf16_f32 v44, v40, v41
    v_lshlrev_b32 v40, 16, v44
    v_and_b32 v41, 0xffff0000, v44
    v_max3_f32 v3, v40, v41, v3
    s_waitcnt vmcnt(42)
    v_mfma_f32_16x16x32_bf16 v[24:27], v[80:83], v[16:19], 0
    v_mfma_f32_16x16x32_bf16 v[28:31], v[84:87], v[20:23], 0
    s_waitcnt vmcnt(40)
    v_mfma_f32_16x16x32_bf16 v[32:35], v[88:91], v[16:19], 0
    v_mfma_f32_16x16x32_bf16 v[36:39], v[92:95], v[20:23], 0
    s_waitcnt lgkmcnt(0)
    v_readfirstlane_b32 s84, v62
    s_nop 0
    s_bfe_u32 s73, s84, 0x40002
    s_lshl_b32 s73, s73, 15
    s_and_b32 s74, s84, 3
    s_lshl_b32 s74, s74, 12
    s_add_u32 s73, s73, s74
    s_cmp_ge_u32 s84, 128
    s_cselect_b32 s73, 0x80000, s73
    s_add_u32 s70, s73, 0x4000
    s_cmp_ge_u32 s84, 64
    s_cbranch_scc1 L_rf3
    buffer_load_dwordx4 v[64:67], v1, s[36:39], s73 offen offset:0 nt
    buffer_load_dwordx4 v[68:71], v1, s[36:39], s73 offen offset:1024 nt
    buffer_load_dwordx4 v[72:75], v1, s[36:39], s73 offen offset:2048 nt
    buffer_load_dwordx4 v[76:79], v1, s[36:39], s73 offen offset:3072 nt
    buffer_load_dwordx4 v[80:83], v1, s[36:39], s70 offen offset:0 nt
    buffer_load_dwordx4 v[84:87], v1, s[36:39], s70 offen offset:1024 nt
    buffer_load_dwordx4 v[88:91], v1, s[36:39], s70 offen offset:2048 nt
    buffer_load_dwordx4 v[92:95], v1, s[36:39], s70 offen offset:3072 nt
    s_branch L_rf3_e
L_rf3:
    buffer_load_dwordx4 v[64:67], v2, s[40:43], s73 offen offset:0 nt
    buffer_load_dwordx4 v[68:71], v2, s[40:43], s73 offen offset:1024 nt
    buffer_load_dwordx4 v[72:75], v2, s[40:43], s73 offen offset:2048 nt
    buffer_load_dwordx4 v[76:79], v2, s[40:43], s73 offen offset:3072 nt
    buffer_load_dwordx4 v[80:83], v2, s[40:43], s70 offen offset:0 nt
    buffer_load_dwordx4 v[84:87], v2, s[40:43], s70 offen offset:1024 nt
    buffer_load_dwordx4 v[88:91], v2, s[40:43], s70 offen offset:2048 nt
    buffer_load_dwordx4 v[92:95], v2, s[40:43], s70 offen offset:3072 nt
L_rf3_e:
    v_cndmask_b32_e64 v24, v28, v24, s[60:61]
    v_cndmask_b32_e64 v32, v36, v32, s[60:61]
    v_cndmask_b32_e64 v25, v29, v25, s[60:61]
    v_cndmask_b32_e64 v33, v37, v33, s[60:61]
    v_cndmask_b32_e64 v26, v30, v26, s[60:61]
    v_cndmask_b32_e64 v34, v38, v34, s[60:61]
    v_cndmask_b32_e64 v27, v31, v27, s[60:61]
    v_cndmask_b32_e64 v35, v39, v35, s[60:61]
    v_mov_b32_dpp v40, v24 quad_perm:[0,0,0,0] row_mask:0xf bank_mask:0xf
    v_mov_b32_dpp v41, v32 quad_perm:[0,0,0,0] row_mask:0xf bank_mask:0xf
    s_nop 0
    v_add_f32_dpp v40, v25, v40 quad_perm:[1,1,1,1] row_mask:0xf bank_mask:0xf
    v_add_f32_dpp v41, v33, v41 quad_perm:[1,1,1,1] row_mask:0xf bank_mask:0xf
    s_nop 0
    v_add_f32_dpp v40, v26, v40 quad_perm:[2,2,2,2] row_mask:0xf bank_mask:0xf
    v_add_f32_dpp v41, v34, v41 quad_perm:[2,2,2,2] row_mask:0xf bank_mask:0xf
    s_nop 0
    v_add_f32_dpp v40, v27, v40 quad_perm:[3,3,3,3] row_mask:0xf bank_mask:0xf
    v_add_f32_dpp v41, v35, v41 quad_perm:[3,3,3,3] row_mask:0xf bank_mask:0xf
    s_nop 0
    v_mov_b32_dpp v40, v40 row_ror:8 row_mask:0xa bank_mask:0xf
    v_mov_b32_dpp v41, v41 row_ror:8 row_mask:0xa bank_mask:0xf
    v_mov_b32 v56, v40
    v_mov_b32 v57, v41
    s_nop 0
    v_permlane16_swap_b32 v40, v56
    v_permlane16_swap_b32 v41, v57
    v_add_f32 v40, v40, v56
    v_add_f32 v41, v41, v57
    v_cvt_pk_bf16_f32 v45, v40, v41
    v_lshlrev_b32 v40, 16, v45
    v_and_b32 v41, 0xffff0000, v45
    v_max3_f32 v3, v40, v41, v3
    v_add_u32 v56, s75, v7
    s_mov_b64 exec, s[76:77]
    ds_write_b64 v56, v[44:45] offset:20992
    s_mov_b64 exec, -1
    s_branch L_N0
L_V0:
    s_cmp_lg_u32 s72, 0
    s_cbranch_scc1 L_VT0
    v_max_f32_dpp v3, v3, v3 row_ror:8 row_mask:0xf bank_mask:0xf
    v_mov_b32 v57, v3
    s_nop 1
    v_permlane32_swap_b32 v3, v57
    v_max_f32 v3, v3, v57
    v_mov_b32 v57, v0
    s_mov_b64 exec, 0x11
    ds_max_f32 v57, v3 offset:2216
    s_waitcnt lgkmcnt(0)
    s_mov_b64 exec, 1
    ds_add_u32 v60, v61 offset:2212
    s_mov_b64 exec, -1
    s_mov_b32 s72, 1
    s_mov_b32 s74, 0
L_lw4:
    ds_read_b32 v62, v60 offset:2212
    s_add_u32 s74, s74, 1
    s_waitcnt lgkmcnt(0)
    v_readfirstlane_b32 s73, v62
    s_cmp_ge_u32 s74, 8388608
    s_nop 3
    s_cbranch_scc1 L_lw4_d
    s_cmp_ge_u32 s73, 4
    s_cbranch_scc0 L_lw4
L_lw4_d:
    v_bfe_u32 v57, v0, 2, 1
    v_lshlrev_b32 v57, 2, v57
    ds_read_b32 v6, v57 offset:2216
    s_waitcnt lgkmcnt(0)
    v_mul_f32 v6, s59, v6
    s_nop 2
L_VT0:
    v_add_u32 v56, s75, v5
    ds_read_b128 v[40:43], v56 offset:20992
    s_mov_b64 exec, 1
    ds_add_rtn_u32 v62, v60, v61 offset:2200
    s_mov_b64 exec, -1
    s_waitcnt lgkmcnt(1)
    v_lshlrev_b32 v24, 16, v40
    v_lshlrev_b32 v25, 16, v42
    v_and_b32 v26, 0xffff0000, v40
    v_and_b32 v27, 0xffff0000, v42
    v_lshlrev_b32 v28, 16, v41
    v_lshlrev_b32 v29, 16, v43
    v_and_b32 v30, 0xffff0000, v41
    v_and_b32 v31, 0xffff0000, v43
    v_fma_f32 v24, v24, s58, v6
    v_fma_f32 v25, v25, s58, v6
    v_fma_f32 v26, v26, s58, v6
    v_fma_f32 v27, v27, s58, v6
    v_fma_f32 v28, v28, s58, v6
    v_fma_f32 v29, v29, s58, v6
    v_fma_f32 v30, v30, s58, v6
    v_fma_f32 v31, v31, s58, v6
    v_exp_f32 v24, v24
    v_exp_f32 v25, v25
    v_exp_f32 v26, v26
    v_exp_f32 v27, v27
    v_exp_f32 v28, v28
    v_exp_f32 v29, v29
    v_exp_f32 v30, v30
    v_exp_f32 v31, v31
    v_cvt_pk_bf16_f32 v44, v24, v25
    v_cvt_pk_bf16_f32 v45, v26, v27
    v_cvt_pk_bf16_f32 v46, v28, v29
    v_cvt_pk_bf16_f32 v47, v30, v31
    v_add_f32 v24, v24, v25
    v_add_f32 v26, v26, v27
    v_add_f32 v28, v28, v29
    v_add_f32 v30, v30, v31
    v_add_f32 v24, v24, v26
    v_add_f32 v28, v28, v30
    v_add_f32 v4, v4, v24
    v_add_f32 v4, v4, v28
    s_waitcnt vmcnt(40)
    v_cndmask_b32_e64 v48, 0, v44, s[62:63]
    v_cndmask_b32_e64 v49, 0, v45, s[62:63]
    v_cndmask_b32_e64 v50, 0, v46, s[62:63]
    v_cndmask_b32_e64 v51, 0, v47, s[62:63]
    v_perm_b32 v24, v68, v64, s56
    v_perm_b32 v25, v76, v72, s56
    v_perm_b32 v26, v84, v80, s56
    v_perm_b32 v27, v92, v88, s56
    s_nop 1
    v_mfma_f32_16x16x32_bf16 v[8:11], v[48:51], v[24:27], v[8:11]
    v_perm_b32 v28, v70, v66, s56
    v_perm_b32 v29, v78, v74, s56
    v_perm_b32 v30, v86, v82, s56
    v_perm_b32 v31, v94, v90, s56
    s_nop 1
    v_mfma_f32_16x16x32_bf16 v[12:15], v[48:51], v[28:31], v[12:15]
    v_cndmask_b32_e64 v52, 0, v44, s[64:65]
    v_cndmask_b32_e64 v53, 0, v45, s[64:65]
    v_cndmask_b32_e64 v54, 0, v46, s[64:65]
    v_cndmask_b32_e64 v55, 0, v47, s[64:65]
    v_perm_b32 v32, v68, v64, s57
    v_perm_b32 v33, v76, v72, s57
    v_perm_b32 v34, v84, v80, s57
    v_perm_b32 v35, v92, v88, s57
    s_nop 1
    v_mfma_f32_16x16x32_bf16 v[8:11], v[52:55], v[32:35], v[8:11]
    v_perm_b32 v36, v70, v66, s57
    v_perm_b32 v37, v78, v74, s57
    v_perm_b32 v38, v86, v82, s57
    v_perm_b32 v39, v94, v90, s57
    s_nop 1
    v_mfma_f32_16x16x32_bf16 v[12:15], v[52:55], v[36:39], v[12:15]
    v_cndmask_b32_e64 v48, 0, v44, s[66:67]
    v_cndmask_b32_e64 v49, 0, v45, s[66:67]
    v_cndmask_b32_e64 v50, 0, v46, s[66:67]
    v_cndmask_b32_e64 v51, 0, v47, s[66:67]
    v_perm_b32 v24, v69, v65, s56
    v_perm_b32 v25, v77, v73, s56
    v_perm_b32 v26, v85, v81, s56
    v_perm_b32 v27, v93, v89, s56
    s_nop 1
    v_mfma_f32_16x16x32_bf16 v[8:11], v[48:51], v[24:27], v[8:11]
    v_perm_b32 v28, v71, v67, s56
    v_perm_b32 v29, v79, v75, s56
    v_perm_b32 v30, v87, v83, s56
    v_perm_b32 v31, v95, v91, s56
    s_nop 1
    v_mfma_f32_16x16x32_bf16 v[12:15], v[48:51], v[28:31], v[12:15]
    v_cndmask_b32_e64 v52, 0, v44, s[68:69]
    v_cndmask_b32_e64 v53, 0, v45, s[68:69]
    v_cndmask_b32_e64 v54, 0, v46, s[68:69]
    v_cndmask_b32_e64 v55, 0, v47, s[68:69]
    v_perm_b32 v32, v69, v65, s57
    v_perm_b32 v33, v77, v73, s57
    v_perm_b32 v34, v85, v81, s57
    v_perm_b32 v35, v93, v89, s57
    s_nop 1
    v_mfma_f32_16x16x32_bf16 v[8:11], v[52:55], v[32:35], v[8:11]
    v_perm_b32 v36, v71, v67, s57
    v_perm_b32 v37, v79, v75, s57
    v_perm_b32 v38, v87, v83, s57
    v_perm_b32 v39, v95, v91, s57
    s_nop 1
    v_mfma_f32_16x16x32_bf16 v[12:15], v[52:55], v[36:39], v[12:15]
    s_waitcnt lgkmcnt(0)
    v_readfirstlane_b32 s84, v62
    s_nop 0
    s_bfe_u32 s73, s84, 0x40002
    s_lshl_b32 s73, s73, 15
    s_and_b32 s74, s84, 3
    s_lshl_b32 s74, s74, 12
    s_add_u32 s73, s73, s74
    s_cmp_ge_u32 s84, 128
    s_cselect_b32 s73, 0x80000, s73
    s_add_u32 s70, s73, 0x4000
    s_cmp_ge_u32 s84, 64
    s_cbranch_scc1 L_rf5
    buffer_load_dwordx4 v[64:67], v1, s[36:39], s73 offen offset:0 nt
    buffer_load_dwordx4 v[68:71], v1, s[36:39], s73 offen offset:1024 nt
    buffer_load_dwordx4 v[72:75], v1, s[36:39], s73 offen offset:2048 nt
    buffer_load_dwordx4 v[76:79], v1, s[36:39], s73 offen offset:3072 nt
    buffer_load_dwordx4 v[80:83], v1, s[36:39], s70 offen offset:0 nt
    buffer_load_dwordx4 v[84:87], v1, s[36:39], s70 offen offset:1024 nt
    buffer_load_dwordx4 v[88:91], v1, s[36:39], s70 offen offset:2048 nt
    buffer_load_dwordx4 v[92:95], v1, s[36:39], s70 offen offset:3072 nt
    s_branch L_rf5_e
L_rf5:
    buffer_load_dwordx4 v[64:67], v2, s[40:43], s73 offen offset:0 nt
    buffer_load_dwordx4 v[68:71], v2, s[40:43], s73 offen offset:1024 nt
    buffer_load_dwordx4 v[72:75], v2, s[40:43], s73 offen offset:2048 nt
    buffer_load_dwordx4 v[76:79], v2, s[40:43], s73 offen offset:3072 nt
    buffer_load_dwordx4 v[80:83], v2, s[40:43], s70 offen offset:0 nt
    buffer_load_dwordx4 v[84:87], v2, s[40:43], s70 offen offset:1024 nt
    buffer_load_dwordx4 v[88:91], v2, s[40:43], s70 offen offset:2048 nt
    buffer_load_dwordx4 v[92:95], v2, s[40:43], s70 offen offset:3072 nt
L_rf5_e:
L_N0:
    s_cmp_ge_u32 s85, 128
    s_cbranch_scc1 L_sdone
    s_and_b32 s75, s85, 63
    s_lshl_b32 s75, s75, 6
    s_cmp_ge_u32 s85, 64
    s_cbranch_scc1 L_V1
    s_mov_b64 exec, 1
    ds_add_rtn_u32 v62, v60, v61 offset:2200
    s_mov_b64 exec, -1
    s_waitcnt vmcnt(46)
    v_mfma_f32_16x16x32_bf16 v[24:27], v[96:99], v[16:19], 0
    v_mfma_f32_16x16x32_bf16 v[28:31], v[100:103], v[20:23], 0
    s_waitcnt vmcnt(44)
    v_mfma_f32_16x16x32_bf16 v[32:35], v[104:107], v[16:19], 0
    v_mfma_f32_16x16x32_bf16 v[36:39], v[108:111], v[20:23], 0
    s_nop 4
    v_cndmask_b32_e64 v24, v28, v24, s[60:61]
    s_nop 1
    v_cndmask_b32_e64 v32, v36, v32, s[60:61]
    v_cndmask_b32_e64 v25, v29, v25, s[60:61]
    v_cndmask_b32_e64 v33, v37, v33, s[60:61]
    v_cndmask_b32_e64 v26, v30, v26, s[60:61]
    v_cndmask_b32_e64 v34, v38, v34, s[60:61]
    v_cndmask_b32_e64 v27, v31, v27, s[60:61]
    v_cndmask_b32_e64 v35, v39, v35, s[60:61]
    v_mov_b32_dpp v40, v24 quad_perm:[0,0,0,0] row_mask:0xf bank_mask:0xf
    v_mov_b32_dpp v41, v32 quad_perm:[0,0,0,0] row_mask:0xf bank_mask:0xf
    s_nop 0
    v_add_f32_dpp v40, v25, v40 quad_perm:[1,1,1,1] row_mask:0xf bank_mask:0xf
    v_add_f32_dpp v41, v33, v41 quad_perm:[1,1,1,1] row_mask:0xf bank_mask:0xf
    s_nop 0
    v_add_f32_dpp v40, v26, v40 quad_perm:[2,2,2,2] row_mask:0xf bank_mask:0xf
    v_add_f32_dpp v41, v34, v41 quad_perm:[2,2,2,2] row_mask:0xf bank_mask:0xf
    s_nop 0
    v_add_f32_dpp v40, v27, v40 quad_perm:[3,3,3,3] row_mask:0xf bank_mask:0xf
    v_add_f32_dpp v41, v35, v41 quad_perm:[3,3,3,3] row_mask:0xf bank_mask:0xf
    s_nop 0
    v_mov_b32_dpp v40, v40 row_ror:8 row_mask:0xa bank_mask:0xf
    v_mov_b32_dpp v41, v41 row_ror:8 row_mask:0xa bank_mask:0xf
    v_mov_b32 v56, v40
    v_mov_b32 v57, v41
    s_nop 0
    v_permlane16_swap_b32 v40, v56
    v_permlane16_swap_b32 v41, v57
    v_add_f32 v40, v40, v56
    v_add_f32 v41, v41, v57
    v_cvt_pk_bf16_f32 v44, v40, v41
    v_lshlrev_b32 v40, 16, v44
    v_and_b32 v41, 0xffff0000, v44
    v_max3_f32 v3, v40, v41, v3
    s_waitcnt vmcnt(42)
    v_mfma_f32_16x16x32_bf16 v[24:27], v[112:115], v[16:19], 0
    v_mfma_f32_16x16x32_bf16 v[28:31], v[116:119], v[20:23], 0
    s_waitcnt vmcnt(40)
    v_mfma_f32_16x16x32_bf16 v[32:35], v[120:123], v[16:19], 0
    v_mfma_f32_16x16x32_bf16 v[36:39], v[124:127], v[20:23], 0
    s_waitcnt lgkmcnt(0)
    v_readfirstlane_b32 s85, v62
    s_nop 0
    s_bfe_u32 s73, s85, 0x40002
    s_lshl_b32 s73, s73, 15
    s_and_b32 s74, s85, 3
    s_lshl_b32 s74, s74, 12
    s_add_u32 s73, s73, s74
    s_cmp_ge_u32 s85, 128
    s_cselect_b32 s73, 0x80000, s73
    s_add_u32 s70, s73, 0x4000
    s_cmp_ge_u32 s85, 64
    s_cbranch_scc1 L_rf6
    buffer_load_dwordx4 v[96:99], v1, s[36:39], s73 offen offset:0 nt
    buffer_load_dwordx4 v[100:103], v1, s[36:39], s73 offen offset:1024 nt
    buffer_load_dwordx4 v[104:107], v1, s[36:39], s73 offen offset:2048 nt
    buffer_load_dwordx4 v[108:111], v1, s[36:39], s73 offen offset:3072 nt
    buffer_load_dwordx4 v[112:115], v1, s[36:39], s70 offen offset:0 nt
    buffer_load_dwordx4 v[116:119], v1, s[36:39], s70 offen offset:1024 nt
    buffer_load_dwordx4 v[120:123], v1, s[36:39], s70 offen offset:2048 nt
    buffer_load_dwordx4 v[124:127], v1, s[36:39], s70 offen offset:3072 nt
    s_branch L_rf6_e
L_rf6:
    buffer_load_dwordx4 v[96:99], v2, s[40:43], s73 offen offset:0 nt
    buffer_load_dwordx4 v[100:103], v2, s[40:43], s73 offen offset:1024 nt
    buffer_load_dwordx4 v[104:107], v2, s[40:43], s73 offen offset:2048 nt
    buffer_load_dwordx4 v[108:111], v2, s[40:43], s73 offen offset:3072 nt
    buffer_load_dwordx4 v[112:115], v2, s[40:43], s70 offen offset:0 nt
    buffer_load_dwordx4 v[116:119], v2, s[40:43], s70 offen offset:1024 nt
    buffer_load_dwordx4 v[120:123], v2, s[40:43], s70 offen offset:2048 nt
    buffer_load_dwordx4 v[124:127], v2, s[40:43], s70 offen offset:3072 nt
L_rf6_e:
    v_cndmask_b32_e64 v24, v28, v24, s[60:61]
    v_cndmask_b32_e64 v32, v36, v32, s[60:61]
    v_cndmask_b32_e64 v25, v29, v25, s[60:61]
    v_cndmask_b32_e64 v33, v37, v33, s[60:61]
    v_cndmask_b32_e64 v26, v30, v26, s[60:61]
    v_cndmask_b32_e64 v34, v38, v34, s[60:61]
    v_cndmask_b32_e64 v27, v31, v27, s[60:61]
    v_cndmask_b32_e64 v35, v39, v35, s[60:61]
    v_mov_b32_dpp v40, v24 quad_perm:[0,0,0,0] row_mask:0xf bank_mask:0xf
    v_mov_b32_dpp v41, v32 quad_perm:[0,0,0,0] row_mask:0xf bank_mask:0xf
    s_nop 0
    v_add_f32_dpp v40, v25, v40 quad_perm:[1,1,1,1] row_mask:0xf bank_mask:0xf
    v_add_f32_dpp v41, v33, v41 quad_perm:[1,1,1,1] row_mask:0xf bank_mask:0xf
    s_nop 0
    v_add_f32_dpp v40, v26, v40 quad_perm:[2,2,2,2] row_mask:0xf bank_mask:0xf
    v_add_f32_dpp v41, v34, v41 quad_perm:[2,2,2,2] row_mask:0xf bank_mask:0xf
    s_nop 0
    v_add_f32_dpp v40, v27, v40 quad_perm:[3,3,3,3] row_mask:0xf bank_mask:0xf
    v_add_f32_dpp v41, v35, v41 quad_perm:[3,3,3,3] row_mask:0xf bank_mask:0xf
    s_nop 0
    v_mov_b32_dpp v40, v40 row_ror:8 row_mask:0xa bank_mask:0xf
    v_mov_b32_dpp v41, v41 row_ror:8 row_mask:0xa bank_mask:0xf
    v_mov_b32 v56, v40
    v_mov_b32 v57, v41
    s_nop 0
    v_permlane16_swap_b32 v40, v56
    v_permlane16_swap_b32 v41, v57
    v_add_f32 v40, v40, v56
    v_add_f32 v41, v41, v57
    v_cvt_pk_bf16_f32 v45, v40, v41
    v_lshlrev_b32 v40, 16, v45
    v_and_b32 v41, 0xffff0000, v45
    v_max3_f32 v3, v40, v41, v3
    v_add_u32 v56, s75, v7
    s_mov_b64 exec, s[76:77]
    ds_write_b64 v56, v[44:45] offset:20992
    s_mov_b64 exec, -1
    s_branch L_N1
L_V1:
    s_cmp_lg_u32 s72, 0
    s_cbranch_scc1 L_VT1
    v_max_f32_dpp v3, v3, v3 row_ror:8 row_mask:0xf bank_mask:0xf
    v_mov_b32 v57, v3
    s_nop 1
    v_permlane32_swap_b32 v3, v57
    v_max_f32 v3, v3, v57
    v_mov_b32 v57, v0
    s_mov_b64 exec, 0x11
    ds_max_f32 v57, v3 offset:2216
    s_waitcnt lgkmcnt(0)
    s_mov_b64 exec, 1
    ds_add_u32 v60, v61 offset:2212
    s_mov_b64 exec, -1
    s_mov_b32 s72, 1
    s_mov_b32 s74, 0
L_lw7:
    ds_read_b32 v62, v60 offset:2212
    s_add_u32 s74, s74, 1
    s_waitcnt lgkmcnt(0)
    v_readfirstlane_b32 s73, v62
    s_cmp_ge_u32 s74, 8388608
    s_nop 3
    s_cbranch_scc1 L_lw7_d
    s_cmp_ge_u32 s73, 4
    s_cbranch_scc0 L_lw7
L_lw7_d:
    v_bfe_u32 v57, v0, 2, 1
    v_lshlrev_b32 v57, 2, v57
    ds_read_b32 v6, v57 offset:2216
    s_waitcnt lgkmcnt(0)
    v_mul_f32 v6, s59, v6
    s_nop 2
L_VT1:
    v_add_u32 v56, s75, v5
    ds_read_b128 v[40:43], v56 offset:20992
    s_mov_b64 exec, 1
    ds_add_rtn_u32 v62, v60, v61 offset:2200
    s_mov_b64 exec, -1
    s_waitcnt lgkmcnt(1)
    v_lshlrev_b32 v24, 16, v40
    v_lshlrev_b32 v25, 16, v42
    v_and_b32 v26, 0xffff0000, v40
    v_and_b32 v27, 0xffff0000, v42
    v_lshlrev_b32 v28, 16, v41
    v_lshlrev_b32 v29, 16, v43
    v_and_b32 v30, 0xffff0000, v41
    v_and_b32 v31, 0xffff0000, v43
    v_fma_f32 v24, v24, s58, v6
    v_fma_f32 v25, v25, s58, v6
    v_fma_f32 v26, v26, s58, v6
    v_fma_f32 v27, v27, s58, v6
    v_fma_f32 v28, v28, s58, v6
    v_fma_f32 v29, v29, s58, v6
    v_fma_f32 v30, v30, s58, v6
    v_fma_f32 v31, v31, s58, v6
    v_exp_f32 v24, v24
    v_exp_f32 v25, v25
    v_exp_f32 v26, v26
    v_exp_f32 v27, v27
    v_exp_f32 v28, v28
    v_exp_f32 v29, v29
    v_exp_f32 v30, v30
    v_exp_f32 v31, v31
    v_cvt_pk_bf16_f32 v44, v24, v25
    v_cvt_pk_bf16_f32 v45, v26, v27
    v_cvt_pk_bf16_f32 v46, v28, v29
    v_cvt_pk_bf16_f32 v47, v30, v31
    v_add_f32 v24, v24, v25
    v_add_f32 v26, v26, v27
    v_add_f32 v28, v28, v29
    v_add_f32 v30, v30, v31
    v_add_f32 v24, v24, v26
    v_add_f32 v28, v28, v30
    v_add_f32 v4, v4, v24
    v_add_f32 v4, v4, v28
    s_waitcnt vmcnt(40)
    v_cndmask_b32_e64 v48, 0, v44, s[62:63]
    v_cndmask_b32_e64 v49, 0, v45, s[62:63]
    v_cndmask_b32_e64 v50, 0, v46, s[62:63]
    v_cndmask_b32_e64 v51, 0, v47, s[62:63]
    v_perm_b32 v24, v100, v96, s56
    v_perm_b32 v25, v108, v104, s56
    v_perm_b32 v26, v116, v112, s56
    v_perm_b32 v27, v124, v120, s56
    s_nop 1
    v_mfma_f32_16x16x32_bf16 v[8:11], v[48:51], v[24:27], v[8:11]
    v_perm_b32 v28, v102, v98, s56
    v_perm_b32 v29, v110, v106, s56
    v_perm_b32 v30, v118, v114, s56
    v_perm_b32 v31, v126, v122, s56
    s_nop 1
    v_mfma_f32_16x16x32_bf16 v[12:15], v[48:51], v[28:31], v[12:15]
    v_cndmask_b32_e64 v52, 0, v44, s[64:65]
    v_cndmask_b32_e64 v53, 0, v45, s[64:65]
    v_cndmask_b32_e64 v54, 0, v46, s[64:65]
    v_cndmask_b32_e64 v55, 0, v47, s[64:65]
    v_perm_b32 v32, v100, v96, s57
    v_perm_b32 v33, v108, v104, s57
    v_perm_b32 v34, v116, v112, s57
    v_perm_b32 v35, v124, v120, s57
    s_nop 1
    v_mfma_f32_16x16x32_bf16 v[8:11], v[52:55], v[32:35], v[8:11]
    v_perm_b32 v36, v102, v98, s57
    v_perm_b32 v37, v110, v106, s57
    v_perm_b32 v38, v118, v114, s57
    v_perm_b32 v39, v126, v122, s57
    s_nop 1
    v_mfma_f32_16x16x32_bf16 v[12:15], v[52:55], v[36:39], v[12:15]
    v_cndmask_b32_e64 v48, 0, v44, s[66:67]
    v_cndmask_b32_e64 v49, 0, v45, s[66:67]
    v_cndmask_b32_e64 v50, 0, v46, s[66:67]
    v_cndmask_b32_e64 v51, 0, v47, s[66:67]
    v_perm_b32 v24, v101, v97, s56
    v_perm_b32 v25, v109, v105, s56
    v_perm_b32 v26, v117, v113, s56
    v_perm_b32 v27, v125, v121, s56
    s_nop 1
    v_mfma_f32_16x16x32_bf16 v[8:11], v[48:51], v[24:27], v[8:11]
    v_perm_b32 v28, v103, v99, s56
    v_perm_b32 v29, v111, v107, s56
    v_perm_b32 v30, v119, v115, s56
    v_perm_b32 v31, v127, v123, s56
    s_nop 1
    v_mfma_f32_16x16x32_bf16 v[12:15], v[48:51], v[28:31], v[12:15]
    v_cndmask_b32_e64 v52, 0, v44, s[68:69]
    v_cndmask_b32_e64 v53, 0, v45, s[68:69]
    v_cndmask_b32_e64 v54, 0, v46, s[68:69]
    v_cndmask_b32_e64 v55, 0, v47, s[68:69]
    v_perm_b32 v32, v101, v97, s57
    v_perm_b32 v33, v109, v105, s57
    v_perm_b32 v34, v117, v113, s57
    v_perm_b32 v35, v125, v121, s57
    s_nop 1
    v_mfma_f32_16x16x32_bf16 v[8:11], v[52:55], v[32:35], v[8:11]
    v_perm_b32 v36, v103, v99, s57
    v_perm_b32 v37, v111, v107, s57
    v_perm_b32 v38, v119, v115, s57
    v_perm_b32 v39, v127, v123, s57
    s_nop 1
    v_mfma_f32_16x16x32_bf16 v[12:15], v[52:55], v[36:39], v[12:15]
    s_waitcnt lgkmcnt(0)
    v_readfirstlane_b32 s85, v62
    s_nop 0
    s_bfe_u32 s73, s85, 0x40002
    s_lshl_b32 s73, s73, 15
    s_and_b32 s74, s85, 3
    s_lshl_b32 s74, s74, 12
    s_add_u32 s73, s73, s74
    s_cmp_ge_u32 s85, 128
    s_cselect_b32 s73, 0x80000, s73
    s_add_u32 s70, s73, 0x4000
    s_cmp_ge_u32 s85, 64
    s_cbranch_scc1 L_rf8
    buffer_load_dwordx4 v[96:99], v1, s[36:39], s73 offen offset:0 nt
    buffer_load_dwordx4 v[100:103], v1, s[36:39], s73 offen offset:1024 nt
    buffer_load_dwordx4 v[104:107], v1, s[36:39], s73 offen offset:2048 nt
    buffer_load_dwordx4 v[108:111], v1, s[36:39], s73 offen offset:3072 nt
    buffer_load_dwordx4 v[112:115], v1, s[36:39], s70 offen offset:0 nt
    buffer_load_dwordx4 v[116:119], v1, s[36:39], s70 offen offset:1024 nt
    buffer_load_dwordx4 v[120:123], v1, s[36:39], s70 offen offset:2048 nt
    buffer_load_dwordx4 v[124:127], v1, s[36:39], s70 offen offset:3072 nt
    s_branch L_rf8_e
L_rf8:
    buffer_load_dwordx4 v[96:99], v2, s[40:43], s73 offen offset:0 nt
    buffer_load_dwordx4 v[100:103], v2, s[40:43], s73 offen offset:1024 nt
    buffer_load_dwordx4 v[104:107], v2, s[40:43], s73 offen offset:2048 nt
    buffer_load_dwordx4 v[108:111], v2, s[40:43], s73 offen offset:3072 nt
    buffer_load_dwordx4 v[112:115], v2, s[40:43], s70 offen offset:0 nt
    buffer_load_dwordx4 v[116:119], v2, s[40:43], s70 offen offset:1024 nt
    buffer_load_dwordx4 v[120:123], v2, s[40:43], s70 offen offset:2048 nt
    buffer_load_dwordx4 v[124:127], v2, s[40:43], s70 offen offset:3072 nt
L_rf8_e:
L_N1:
    s_cmp_ge_u32 s86, 128
    s_cbranch_scc1 L_sdone
    s_and_b32 s75, s86, 63
    s_lshl_b32 s75, s75, 6
    s_cmp_ge_u32 s86, 64
    s_cbranch_scc1 L_V2
    s_mov_b64 exec, 1
    ds_add_rtn_u32 v62, v60, v61 offset:2200
    s_mov_b64 exec, -1
    s_waitcnt vmcnt(46)
    v_mfma_f32_16x16x32_bf16 v[24:27], v[128:131], v[16:19], 0
    v_mfma_f32_16x16x32_bf16 v[28:31], v[132:135], v[20:23], 0
    s_waitcnt vmcnt(44)
    v_mfma_f32_16x16x32_bf16 v[32:35], v[136:139], v[16:19], 0
    v_mfma_f32_16x16x32_bf16 v[36:39], v[140:143], v[20:23], 0
    s_nop 4
    v_cndmask_b32_e64 v24, v28, v24, s[60:61]
    s_nop 1
    v_cndmask_b32_e64 v32, v36, v32, s[60:61]
    v_cndmask_b32_e64 v25, v29, v25, s[60:61]
    v_cndmask_b32_e64 v33, v37, v33, s[60:61]
    v_cndmask_b32_e64 v26, v30, v26, s[60:61]
    v_cndmask_b32_e64 v34, v38, v34, s[60:61]
    v_cndmask_b32_e64 v27, v31, v27, s[60:61]
    v_cndmask_b32_e64 v35, v39, v35, s[60:61]
    v_mov_b32_dpp v40, v24 quad_perm:[0,0,0,0] row_mask:0xf bank_mask:0xf
    v_mov_b32_dpp v41, v32 quad_perm:[0,0,0,0] row_mask:0xf bank_mask:0xf
    s_nop 0
    v_add_f32_dpp v40, v25, v40 quad_perm:[1,1,1,1] row_mask:0xf bank_mask:0xf
    v_add_f32_dpp v41, v33, v41 quad_perm:[1,1,1,1] row_mask:0xf bank_mask:0xf
    s_nop 0
    v_add_f32_dpp v40, v26, v40 quad_perm:[2,2,2,2] row_mask:0xf bank_mask:0xf
    v_add_f32_dpp v41, v34, v41 quad_perm:[2,2,2,2] row_mask:0xf bank_mask:0xf
    s_nop 0
    v_add_f32_dpp v40, v27, v40 quad_perm:[3,3,3,3] row_mask:0xf bank_mask:0xf
    v_add_f32_dpp v41, v35, v41 quad_perm:[3,3,3,3] row_mask:0xf bank_mask:0xf
    s_nop 0
    v_mov_b32_dpp v40, v40 row_ror:8 row_mask:0xa bank_mask:0xf
    v_mov_b32_dpp v41, v41 row_ror:8 row_mask:0xa bank_mask:0xf
    v_mov_b32 v56, v40
    v_mov_b32 v57, v41
    s_nop 0
    v_permlane16_swap_b32 v40, v56
    v_permlane16_swap_b32 v41, v57
    v_add_f32 v40, v40, v56
    v_add_f32 v41, v41, v57
    v_cvt_pk_bf16_f32 v44, v40, v41
    v_lshlrev_b32 v40, 16, v44
    v_and_b32 v41, 0xffff0000, v44
    v_max3_f32 v3, v40, v41, v3
    s_waitcnt vmcnt(42)
    v_mfma_f32_16x16x32_bf16 v[24:27], v[144:147], v[16:19], 0
    v_mfma_f32_16x16x32_bf16 v[28:31], v[148:151], v[20:23], 0
    s_waitcnt vmcnt(40)
    v_mfma_f32_16x16x32_bf16 v[32:35], v[152:155], v[16:19], 0
    v_mfma_f32_16x16x32_bf16 v[36:39], v[156:159], v[20:23], 0
    s_waitcnt lgkmcnt(0)
    v_readfirstlane_b32 s86, v62
    s_nop 0
    s_bfe_u32 s73, s86, 0x40002
    s_lshl_b32 s73, s73, 15
    s_and_b32 s74, s86, 3
    s_lshl_b32 s74, s74, 12
    s_add_u32 s73, s73, s74
    s_cmp_ge_u32 s86, 128
    s_cselect_b32 s73, 0x80000, s73
    s_add_u32 s70, s73, 0x4000
    s_cmp_ge_u32 s86, 64
    s_cbranch_scc1 L_rf9
    buffer_load_dwordx4 v[128:131], v1, s[36:39], s73 offen offset:0 nt
    buffer_load_dwordx4 v[132:135], v1, s[36:39], s73 offen offset:1024 nt
    buffer_load_dwordx4 v[136:139], v1, s[36:39], s73 offen offset:2048 nt
    buffer_load_dwordx4 v[140:143], v1, s[36:39], s73 offen offset:3072 nt
    buffer_load_dwordx4 v[144:147], v1, s[36:39], s70 offen offset:0 nt
    buffer_load_dwordx4 v[148:151], v1, s[36:39], s70 offen offset:1024 nt
    buffer_load_dwordx4 v[152:155], v1, s[36:39], s70 offen offset:2048 nt
    buffer_load_dwordx4 v[156:159], v1, s[36:39], s70 offen offset:3072 nt
    s_branch L_rf9_e
L_rf9:
    buffer_load_dwordx4 v[128:131], v2, s[40:43], s73 offen offset:0 nt
    buffer_load_dwordx4 v[132:135], v2, s[40:43], s73 offen offset:1024 nt
    buffer_load_dwordx4 v[136:139], v2, s[40:43], s73 offen offset:2048 nt
    buffer_load_dwordx4 v[140:143], v2, s[40:43], s73 offen offset:3072 nt
    buffer_load_dwordx4 v[144:147], v2, s[40:43], s70 offen offset:0 nt
    buffer_load_dwordx4 v[148:151], v2, s[40:43], s70 offen offset:1024 nt
    buffer_load_dwordx4 v[152:155], v2, s[40:43], s70 offen offset:2048 nt
    buffer_load_dwordx4 v[156:159], v2, s[40:43], s70 offen offset:3072 nt
L_rf9_e:
    v_cndmask_b32_e64 v24, v28, v24, s[60:61]
    v_cndmask_b32_e64 v32, v36, v32, s[60:61]
    v_cndmask_b32_e64 v25, v29, v25, s[60:61]
    v_cndmask_b32_e64 v33, v37, v33, s[60:61]
    v_cndmask_b32_e64 v26, v30, v26, s[60:61]
    v_cndmask_b32_e64 v34, v38, v34, s[60:61]
    v_cndmask_b32_e64 v27, v31, v27, s[60:61]
    v_cndmask_b32_e64 v35, v39, v35, s[60:61]
    v_mov_b32_dpp v40, v24 quad_perm:[0,0,0,0] row_mask:0xf bank_mask:0xf
    v_mov_b32_dpp v41, v32 quad_perm:[0,0,0,0] row_mask:0xf bank_mask:0xf
    s_nop 0
    v_add_f32_dpp v40, v25, v40 quad_perm:[1,1,1,1] row_mask:0xf bank_mask:0xf
    v_add_f32_dpp v41, v33, v41 quad_perm:[1,1,1,1] row_mask:0xf bank_mask:0xf
    s_nop 0
    v_add_f32_dpp v40, v26, v40 quad_perm:[2,2,2,2] row_mask:0xf bank_mask:0xf
    v_add_f32_dpp v41, v34, v41 quad_perm:[2,2,2,2] row_mask:0xf bank_mask:0xf
    s_nop 0
    v_add_f32_dpp v40, v27, v40 quad_perm:[3,3,3,3] row_mask:0xf bank_mask:0xf
    v_add_f32_dpp v41, v35, v41 quad_perm:[3,3,3,3] row_mask:0xf bank_mask:0xf
    s_nop 0
    v_mov_b32_dpp v40, v40 row_ror:8 row_mask:0xa bank_mask:0xf
    v_mov_b32_dpp v41, v41 row_ror:8 row_mask:0xa bank_mask:0xf
    v_mov_b32 v56, v40
    v_mov_b32 v57, v41
    s_nop 0
    v_permlane16_swap_b32 v40, v56
    v_permlane16_swap_b32 v41, v57
    v_add_f32 v40, v40, v56
    v_add_f32 v41, v41, v57
    v_cvt_pk_bf16_f32 v45, v40, v41
    v_lshlrev_b32 v40, 16, v45
    v_and_b32 v41, 0xffff0000, v45
    v_max3_f32 v3, v40, v41, v3
    v_add_u32 v56, s75, v7
    s_mov_b64 exec, s[76:77]
    ds_write_b64 v56, v[44:45] offset:20992
    s_mov_b64 exec, -1
    s_branch L_N2
L_V2:
    s_cmp_lg_u32 s72, 0
    s_cbranch_scc1 L_VT2
    v_max_f32_dpp v3, v3, v3 row_ror:8 row_mask:0xf bank_mask:0xf
    v_mov_b32 v57, v3
    s_nop 1
    v_permlane32_swap_b32 v3, v57
    v_max_f32 v3, v3, v57
    v_mov_b32 v57, v0
    s_mov_b64 exec, 0x11
    ds_max_f32 v57, v3 offset:2216
    s_waitcnt lgkmcnt(0)
    s_mov_b64 exec, 1
    ds_add_u32 v60, v61 offset:2212
    s_mov_b64 exec, -1
    s_mov_b32 s72, 1
    s_mov_b32 s74, 0
L_lw10:
    ds_read_b32 v62, v60 offset:2212
    s_add_u32 s74, s74, 1
    s_waitcnt lgkmcnt(0)
    v_readfirstlane_b32 s73, v62
    s_cmp_ge_u32 s74, 8388608
    s_nop 3
    s_cbranch_scc1 L_lw10_d
    s_cmp_ge_u32 s73, 4
    s_cbranch_scc0 L_lw10
L_lw10_d:
    v_bfe_u32 v57, v0, 2, 1
    v_lshlrev_b32 v57, 2, v57
    ds_read_b32 v6, v57 offset:2216
    s_waitcnt lgkmcnt(0)
    v_mul_f32 v6, s59, v6
    s_nop 2
L_VT2:
    v_add_u32 v56, s75, v5
    ds_read_b128 v[40:43], v56 offset:20992
    s_mov_b64 exec, 1
    ds_add_rtn_u32 v62, v60, v61 offset:2200
    s_mov_b64 exec, -1
    s_waitcnt lgkmcnt(1)
    v_lshlrev_b32 v24, 16, v40
    v_lshlrev_b32 v25, 16, v42
    v_and_b32 v26, 0xffff0000, v40
    v_and_b32 v27, 0xffff0000, v42
    v_lshlrev_b32 v28, 16, v41
    v_lshlrev_b32 v29, 16, v43
    v_and_b32 v30, 0xffff0000, v41
    v_and_b32 v31, 0xffff0000, v43
    v_fma_f32 v24, v24, s58, v6
    v_fma_f32 v25, v25, s58, v6
    v_fma_f32 v26, v26, s58, v6
    v_fma_f32 v27, v27, s58, v6
    v_fma_f32 v28, v28, s58, v6
    v_fma_f32 v29, v29, s58, v6
    v_fma_f32 v30, v30, s58, v6
    v_fma_f32 v31, v31, s58, v6
    v_exp_f32 v24, v24
    v_exp_f32 v25, v25
    v_exp_f32 v26, v26
    v_exp_f32 v27, v27
    v_exp_f32 v28, v28
    v_exp_f32 v29, v29
    v_exp_f32 v30, v30
    v_exp_f32 v31, v31
    v_cvt_pk_bf16_f32 v44, v24, v25
    v_cvt_pk_bf16_f32 v45, v26, v27
    v_cvt_pk_bf16_f32 v46, v28, v29
    v_cvt_pk_bf16_f32 v47, v30, v31
    v_add_f32 v24, v24, v25
    v_add_f32 v26, v26, v27
    v_add_f32 v28, v28, v29
    v_add_f32 v30, v30, v31
    v_add_f32 v24, v24, v26
    v_add_f32 v28, v28, v30
    v_add_f32 v4, v4, v24
    v_add_f32 v4, v4, v28
    s_waitcnt vmcnt(40)
    v_cndmask_b32_e64 v48, 0, v44, s[62:63]
    v_cndmask_b32_e64 v49, 0, v45, s[62:63]
    v_cndmask_b32_e64 v50, 0, v46, s[62:63]
    v_cndmask_b32_e64 v51, 0, v47, s[62:63]
    v_perm_b32 v24, v132, v128, s56
    v_perm_b32 v25, v140, v136, s56
    v_perm_b32 v26, v148, v144, s56
    v_perm_b32 v27, v156, v152, s56
    s_nop 1
    v_mfma_f32_16x16x32_bf16 v[8:11], v[48:51], v[24:27], v[8:11]
    v_perm_b32 v28, v134, v130, s56
    v_perm_b32 v29, v142, v138, s56
    v_perm_b32 v30, v150, v146, s56
    v_perm_b32 v31, v158, v154, s56
    s_nop 1
    v_mfma_f32_16x16x32_bf16 v[12:15], v[48:51], v[28:31], v[12:15]
    v_cndmask_b32_e64 v52, 0, v44, s[64:65]
    v_cndmask_b32_e64 v53, 0, v45, s[64:65]
    v_cndmask_b32_e64 v54, 0, v46, s[64:65]
    v_cndmask_b32_e64 v55, 0, v47, s[64:65]
    v_perm_b32 v32, v132, v128, s57
    v_perm_b32 v33, v140, v136, s57
    v_perm_b32 v34, v148, v144, s57
    v_perm_b32 v35, v156, v152, s57
    s_nop 1
    v_mfma_f32_16x16x32_bf16 v[8:11], v[52:55], v[32:35], v[8:11]
    v_perm_b32 v36, v134, v130, s57
    v_perm_b32 v37, v142, v138, s57
    v_perm_b32 v38, v150, v146, s57
    v_perm_b32 v39, v158, v154, s57
    s_nop 1
    v_mfma_f32_16x16x32_bf16 v[12:15], v[52:55], v[36:39], v[12:15]
    v_cndmask_b32_e64 v48, 0, v44, s[66:67]
    v_cndmask_b32_e64 v49, 0, v45, s[66:67]
    v_cndmask_b32_e64 v50, 0, v46, s[66:67]
    v_cndmask_b32_e64 v51, 0, v47, s[66:67]
    v_perm_b32 v24, v133, v129, s56
    v_perm_b32 v25, v141, v137, s56
    v_perm_b32 v26, v149, v145, s56
    v_perm_b32 v27, v157, v153, s56
    s_nop 1
    v_mfma_f32_16x16x32_bf16 v[8:11], v[48:51], v[24:27], v[8:11]
    v_perm_b32 v28, v135, v131, s56
    v_perm_b32 v29, v143, v139, s56
    v_perm_b32 v30, v151, v147, s56
    v_perm_b32 v31, v159, v155, s56
    s_nop 1
    v_mfma_f32_16x16x32_bf16 v[12:15], v[48:51], v[28:31], v[12:15]
    v_cndmask_b32_e64 v52, 0, v44, s[68:69]
    v_cndmask_b32_e64 v53, 0, v45, s[68:69]
    v_cndmask_b32_e64 v54, 0, v46, s[68:69]
    v_cndmask_b32_e64 v55, 0, v47, s[68:69]
    v_perm_b32 v32, v133, v129, s57
    v_perm_b32 v33, v141, v137, s57
    v_perm_b32 v34, v149, v145, s57
    v_perm_b32 v35, v157, v153, s57
    s_nop 1
    v_mfma_f32_16x16x32_bf16 v[8:11], v[52:55], v[32:35], v[8:11]
    v_perm_b32 v36, v135, v131, s57
    v_perm_b32 v37, v143, v139, s57
    v_perm_b32 v38, v151, v147, s57
    v_perm_b32 v39, v159, v155, s57
    s_nop 1
    v_mfma_f32_16x16x32_bf16 v[12:15], v[52:55], v[36:39], v[12:15]
    s_waitcnt lgkmcnt(0)
    v_readfirstlane_b32 s86, v62
    s_nop 0
    s_bfe_u32 s73, s86, 0x40002
    s_lshl_b32 s73, s73, 15
    s_and_b32 s74, s86, 3
    s_lshl_b32 s74, s74, 12
    s_add_u32 s73, s73, s74
    s_cmp_ge_u32 s86, 128
    s_cselect_b32 s73, 0x80000, s73
    s_add_u32 s70, s73, 0x4000
    s_cmp_ge_u32 s86, 64
    s_cbranch_scc1 L_rf11
    buffer_load_dwordx4 v[128:131], v1, s[36:39], s73 offen offset:0 nt
    buffer_load_dwordx4 v[132:135], v1, s[36:39], s73 offen offset:1024 nt
    buffer_load_dwordx4 v[136:139], v1, s[36:39], s73 offen offset:2048 nt
    buffer_load_dwordx4 v[140:143], v1, s[36:39], s73 offen offset:3072 nt
    buffer_load_dwordx4 v[144:147], v1, s[36:39], s70 offen offset:0 nt
    buffer_load_dwordx4 v[148:151], v1, s[36:39], s70 offen offset:1024 nt
    buffer_load_dwordx4 v[152:155], v1, s[36:39], s70 offen offset:2048 nt
    buffer_load_dwordx4 v[156:159], v1, s[36:39], s70 offen offset:3072 nt
    s_branch L_rf11_e
L_rf11:
    buffer_load_dwordx4 v[128:131], v2, s[40:43], s73 offen offset:0 nt
    buffer_load_dwordx4 v[132:135], v2, s[40:43], s73 offen offset:1024 nt
    buffer_load_dwordx4 v[136:139], v2, s[40:43], s73 offen offset:2048 nt
    buffer_load_dwordx4 v[140:143], v2, s[40:43], s73 offen offset:3072 nt
    buffer_load_dwordx4 v[144:147], v2, s[40:43], s70 offen offset:0 nt
    buffer_load_dwordx4 v[148:151], v2, s[40:43], s70 offen offset:1024 nt
    buffer_load_dwordx4 v[152:155], v2, s[40:43], s70 offen offset:2048 nt
    buffer_load_dwordx4 v[156:159], v2, s[40:43], s70 offen offset:3072 nt
L_rf11_e:
L_N2:
    s_cmp_ge_u32 s87, 128
    s_cbranch_scc1 L_sdone
    s_and_b32 s75, s87, 63
    s_lshl_b32 s75, s75, 6
    s_cmp_ge_u32 s87, 64
    s_cbranch_scc1 L_V3
    s_mov_b64 exec, 1
    ds_add_rtn_u32 v62, v60, v61 offset:2200
    s_mov_b64 exec, -1
    s_waitcnt vmcnt(46)
    v_mfma_f32_16x16x32_bf16 v[24:27], v[160:163], v[16:19], 0
    v_mfma_f32_16x16x32_bf16 v[28:31], v[164:167], v[20:23], 0
    s_waitcnt vmcnt(44)
    v_mfma_f32_16x16x32_bf16 v[32:35], v[168:171], v[16:19], 0
    v_mfma_f32_16x16x32_bf16 v[36:39], v[172:175], v[20:23], 0
    s_nop 4
    v_cndmask_b32_e64 v24, v28, v24, s[60:61]
    s_nop 1
    v_cndmask_b32_e64 v32, v36, v32, s[60:61]
    v_cndmask_b32_e64 v25, v29, v25, s[60:61]
    v_cndmask_b32_e64 v33, v37, v33, s[60:61]
    v_cndmask_b32_e64 v26, v30, v26, s[60:61]
    v_cndmask_b32_e64 v34, v38, v34, s[60:61]
    v_cndmask_b32_e64 v27, v31, v27, s[60:61]
    v_cndmask_b32_e64 v35, v39, v35, s[60:61]
    v_mov_b32_dpp v40, v24 quad_perm:[0,0,0,0] row_mask:0xf bank_mask:0xf
    v_mov_b32_dpp v41, v32 quad_perm:[0,0,0,0] row_mask:0xf bank_mask:0xf
    s_nop 0
    v_add_f32_dpp v40, v25, v40 quad_perm:[1,1,1,1] row_mask:0xf bank_mask:0xf
    v_add_f32_dpp v41, v33, v41 quad_perm:[1,1,1,1] row_mask:0xf bank_mask:0xf
    s_nop 0
    v_add_f32_dpp v40, v26, v40 quad_perm:[2,2,2,2] row_mask:0xf bank_mask:0xf
    v_add_f32_dpp v41, v34, v41 quad_perm:[2,2,2,2] row_mask:0xf bank_mask:0xf
    s_nop 0
    v_add_f32_dpp v40, v27, v40 quad_perm:[3,3,3,3] row_mask:0xf bank_mask:0xf
    v_add_f32_dpp v41, v35, v41 quad_perm:[3,3,3,3] row_mask:0xf bank_mask:0xf
    s_nop 0
    v_mov_b32_dpp v40, v40 row_ror:8 row_mask:0xa bank_mask:0xf
    v_mov_b32_dpp v41, v41 row_ror:8 row_mask:0xa bank_mask:0xf
    v_mov_b32 v56, v40
    v_mov_b32 v57, v41
    s_nop 0
    v_permlane16_swap_b32 v40, v56
    v_permlane16_swap_b32 v41, v57
    v_add_f32 v40, v40, v56
    v_add_f32 v41, v41, v57
    v_cvt_pk_bf16_f32 v44, v40, v41
    v_lshlrev_b32 v40, 16, v44
    v_and_b32 v41, 0xffff0000, v44
    v_max3_f32 v3, v40, v41, v3
    s_waitcnt vmcnt(42)
    v_mfma_f32_16x16x32_bf16 v[24:27], v[176:179], v[16:19], 0
    v_mfma_f32_16x16x32_bf16 v[28:31], v[180:183], v[20:23], 0
    s_waitcnt vmcnt(40)
    v_mfma_f32_16x16x32_bf16 v[32:35], v[184:187], v[16:19], 0
    v_mfma_f32_16x16x32_bf16 v[36:39], v[188:191], v[20:23], 0
    s_waitcnt lgkmcnt(0)
    v_readfirstlane_b32 s87, v62
    s_nop 0
    s_bfe_u32 s73, s87, 0x40002
    s_lshl_b32 s73, s73, 15
    s_and_b32 s74, s87, 3
    s_lshl_b32 s74, s74, 12
    s_add_u32 s73, s73, s74
    s_cmp_ge_u32 s87, 128
    s_cselect_b32 s73, 0x80000, s73
    s_add_u32 s70, s73, 0x4000
    s_cmp_ge_u32 s87, 64
    s_cbranch_scc1 L_rf12
    buffer_load_dwordx4 v[160:163], v1, s[36:39], s73 offen offset:0 nt
    buffer_load_dwordx4 v[164:167], v1, s[36:39], s73 offen offset:1024 nt
    buffer_load_dwordx4 v[168:171], v1, s[36:39], s73 offen offset:2048 nt
    buffer_load_dwordx4 v[172:175], v1, s[36:39], s73 offen offset:3072 nt
    buffer_load_dwordx4 v[176:179], v1, s[36:39], s70 offen offset:0 nt
    buffer_load_dwordx4 v[180:183], v1, s[36:39], s70 offen offset:1024 nt
    buffer_load_dwordx4 v[184:187], v1, s[36:39], s70 offen offset:2048 nt
    buffer_load_dwordx4 v[188:191], v1, s[36:39], s70 offen offset:3072 nt
    s_branch L_rf12_e
L_rf12:
    buffer_load_dwordx4 v[160:163], v2, s[40:43], s73 offen offset:0 nt
    buffer_load_dwordx4 v[164:167], v2, s[40:43], s73 offen offset:1024 nt
    buffer_load_dwordx4 v[168:171], v2, s[40:43], s73 offen offset:2048 nt
    buffer_load_dwordx4 v[172:175], v2, s[40:43], s73 offen offset:3072 nt
    buffer_load_dwordx4 v[176:179], v2, s[40:43], s70 offen offset:0 nt
    buffer_load_dwordx4 v[180:183], v2, s[40:43], s70 offen offset:1024 nt
    buffer_load_dwordx4 v[184:187], v2, s[40:43], s70 offen offset:2048 nt
    buffer_load_dwordx4 v[188:191], v2, s[40:43], s70 offen offset:3072 nt
L_rf12_e:
    v_cndmask_b32_e64 v24, v28, v24, s[60:61]
    v_cndmask_b32_e64 v32, v36, v32, s[60:61]
    v_cndmask_b32_e64 v25, v29, v25, s[60:61]
    v_cndmask_b32_e64 v33, v37, v33, s[60:61]
    v_cndmask_b32_e64 v26, v30, v26, s[60:61]
    v_cndmask_b32_e64 v34, v38, v34, s[60:61]
    v_cndmask_b32_e64 v27, v31, v27, s[60:61]
    v_cndmask_b32_e64 v35, v39, v35, s[60:61]
    v_mov_b32_dpp v40, v24 quad_perm:[0,0,0,0] row_mask:0xf bank_mask:0xf
    v_mov_b32_dpp v41, v32 quad_perm:[0,0,0,0] row_mask:0xf bank_mask:0xf
    s_nop 0
    v_add_f32_dpp v40, v25, v40 quad_perm:[1,1,1,1] row_mask:0xf bank_mask:0xf
    v_add_f32_dpp v41, v33, v41 quad_perm:[1,1,1,1] row_mask:0xf bank_mask:0xf
    s_nop 0
    v_add_f32_dpp v40, v26, v40 quad_perm:[2,2,2,2] row_mask:0xf bank_mask:0xf
    v_add_f32_dpp v41, v34, v41 quad_perm:[2,2,2,2] row_mask:0xf bank_mask:0xf
    s_nop 0
    v_add_f32_dpp v40, v27, v40 quad_perm:[3,3,3,3] row_mask:0xf bank_mask:0xf
    v_add_f32_dpp v41, v35, v41 quad_perm:[3,3,3,3] row_mask:0xf bank_mask:0xf
    s_nop 0
    v_mov_b32_dpp v40, v40 row_ror:8 row_mask:0xa bank_mask:0xf
    v_mov_b32_dpp v41, v41 row_ror:8 row_mask:0xa bank_mask:0xf
    v_mov_b32 v56, v40
    v_mov_b32 v57, v41
    s_nop 0
    v_permlane16_swap_b32 v40, v56
    v_permlane16_swap_b32 v41, v57
    v_add_f32 v40, v40, v56
    v_add_f32 v41, v41, v57
    v_cvt_pk_bf16_f32 v45, v40, v41
    v_lshlrev_b32 v40, 16, v45
    v_and_b32 v41, 0xffff0000, v45
    v_max3_f32 v3, v40, v41, v3
    v_add_u32 v56, s75, v7
    s_mov_b64 exec, s[76:77]
    ds_write_b64 v56, v[44:45] offset:20992
    s_mov_b64 exec, -1
    s_branch L_N3
L_V3:
    s_cmp_lg_u32 s72, 0
    s_cbranch_scc1 L_VT3
    v_max_f32_dpp v3, v3, v3 row_ror:8 row_mask:0xf bank_mask:0xf
    v_mov_b32 v57, v3
    s_nop 1
    v_permlane32_swap_b32 v3, v57
    v_max_f32 v3, v3, v57
    v_mov_b32 v57, v0
    s_mov_b64 exec, 0x11
    ds_max_f32 v57, v3 offset:2216
    s_waitcnt lgkmcnt(0)
    s_mov_b64 exec, 1
    ds_add_u32 v60, v61 offset:2212
    s_mov_b64 exec, -1
    s_mov_b32 s72, 1
    s_mov_b32 s74, 0
L_lw13:
    ds_read_b32 v62, v60 offset:2212
    s_add_u32 s74, s74, 1
    s_waitcnt lgkmcnt(0)
    v_readfirstlane_b32 s73, v62
    s_cmp_ge_u32 s74, 8388608
    s_nop 3
    s_cbranch_scc1 L_lw13_d
    s_cmp_ge_u32 s73, 4
    s_cbranch_scc0 L_lw13
L_lw13_d:
    v_bfe_u32 v57, v0, 2, 1
    v_lshlrev_b32 v57, 2, v57
    ds_read_b32 v6, v57 offset:2216
    s_waitcnt lgkmcnt(0)
    v_mul_f32 v6, s59, v6
    s_nop 2
L_VT3:
    v_add_u32 v56, s75, v5
    ds_read_b128 v[40:43], v56 offset:20992
    s_mov_b64 exec, 1
    ds_add_rtn_u32 v62, v60, v61 offset:2200
    s_mov_b64 exec, -1
    s_waitcnt lgkmcnt(1)
    v_lshlrev_b32 v24, 16, v40
    v_lshlrev_b32 v25, 16, v42
    v_and_b32 v26, 0xffff0000, v40
    v_and_b32 v27, 0xffff0000, v42
    v_lshlrev_b32 v28, 16, v41
    v_lshlrev_b32 v29, 16, v43
    v_and_b32 v30, 0xffff0000, v41
    v_and_b32 v31, 0xffff0000, v43
    v_fma_f32 v24, v24, s58, v6
    v_fma_f32 v25, v25, s58, v6
    v_fma_f32 v26, v26, s58, v6
    v_fma_f32 v27, v27, s58, v6
    v_fma_f32 v28, v28, s58, v6
    v_fma_f32 v29, v29, s58, v6
    v_fma_f32 v30, v30, s58, v6
    v_fma_f32 v31, v31, s58, v6
    v_exp_f32 v24, v24
    v_exp_f32 v25, v25
    v_exp_f32 v26, v26
    v_exp_f32 v27, v27
    v_exp_f32 v28, v28
    v_exp_f32 v29, v29
    v_exp_f32 v30, v30
    v_exp_f32 v31, v31
    v_cvt_pk_bf16_f32 v44, v24, v25
    v_cvt_pk_bf16_f32 v45, v26, v27
    v_cvt_pk_bf16_f32 v46, v28, v29
    v_cvt_pk_bf16_f32 v47, v30, v31
    v_add_f32 v24, v24, v25
    v_add_f32 v26, v26, v27
    v_add_f32 v28, v28, v29
    v_add_f32 v30, v30, v31
    v_add_f32 v24, v24, v26
    v_add_f32 v28, v28, v30
    v_add_f32 v4, v4, v24
    v_add_f32 v4, v4, v28
    s_waitcnt vmcnt(40)
    v_cndmask_b32_e64 v48, 0, v44, s[62:63]
    v_cndmask_b32_e64 v49, 0, v45, s[62:63]
    v_cndmask_b32_e64 v50, 0, v46, s[62:63]
    v_cndmask_b32_e64 v51, 0, v47, s[62:63]
    v_perm_b32 v24, v164, v160, s56
    v_perm_b32 v25, v172, v168, s56
    v_perm_b32 v26, v180, v176, s56
    v_perm_b32 v27, v188, v184, s56
    s_nop 1
    v_mfma_f32_16x16x32_bf16 v[8:11], v[48:51], v[24:27], v[8:11]
    v_perm_b32 v28, v166, v162, s56
    v_perm_b32 v29, v174, v170, s56
    v_perm_b32 v30, v182, v178, s56
    v_perm_b32 v31, v190, v186, s56
    s_nop 1
    v_mfma_f32_16x16x32_bf16 v[12:15], v[48:51], v[28:31], v[12:15]
    v_cndmask_b32_e64 v52, 0, v44, s[64:65]
    v_cndmask_b32_e64 v53, 0, v45, s[64:65]
    v_cndmask_b32_e64 v54, 0, v46, s[64:65]
    v_cndmask_b32_e64 v55, 0, v47, s[64:65]
    v_perm_b32 v32, v164, v160, s57
    v_perm_b32 v33, v172, v168, s57
    v_perm_b32 v34, v180, v176, s57
    v_perm_b32 v35, v188, v184, s57
    s_nop 1
    v_mfma_f32_16x16x32_bf16 v[8:11], v[52:55], v[32:35], v[8:11]
    v_perm_b32 v36, v166, v162, s57
    v_perm_b32 v37, v174, v170, s57
    v_perm_b32 v38, v182, v178, s57
    v_perm_b32 v39, v190, v186, s57
    s_nop 1
    v_mfma_f32_16x16x32_bf16 v[12:15], v[52:55], v[36:39], v[12:15]
    v_cndmask_b32_e64 v48, 0, v44, s[66:67]
    v_cndmask_b32_e64 v49, 0, v45, s[66:67]
    v_cndmask_b32_e64 v50, 0, v46, s[66:67]
    v_cndmask_b32_e64 v51, 0, v47, s[66:67]
    v_perm_b32 v24, v165, v161, s56
    v_perm_b32 v25, v173, v169, s56
    v_perm_b32 v26, v181, v177, s56
    v_perm_b32 v27, v189, v185, s56
    s_nop 1
    v_mfma_f32_16x16x32_bf16 v[8:11], v[48:51], v[24:27], v[8:11]
    v_perm_b32 v28, v167, v163, s56
    v_perm_b32 v29, v175, v171, s56
    v_perm_b32 v30, v183, v179, s56
    v_perm_b32 v31, v191, v187, s56
    s_nop 1
    v_mfma_f32_16x16x32_bf16 v[12:15], v[48:51], v[28:31], v[12:15]
    v_cndmask_b32_e64 v52, 0, v44, s[68:69]
    v_cndmask_b32_e64 v53, 0, v45, s[68:69]
    v_cndmask_b32_e64 v54, 0, v46, s[68:69]
    v_cndmask_b32_e64 v55, 0, v47, s[68:69]
    v_perm_b32 v32, v165, v161, s57
    v_perm_b32 v33, v173, v169, s57
    v_perm_b32 v34, v181, v177, s57
    v_perm_b32 v35, v189, v185, s57
    s_nop 1
    v_mfma_f32_16x16x32_bf16 v[8:11], v[52:55], v[32:35], v[8:11]
    v_perm_b32 v36, v167, v163, s57
    v_perm_b32 v37, v175, v171, s57
    v_perm_b32 v38, v183, v179, s57
    v_perm_b32 v39, v191, v187, s57
    s_nop 1
    v_mfma_f32_16x16x32_bf16 v[12:15], v[52:55], v[36:39], v[12:15]
    s_waitcnt lgkmcnt(0)
    v_readfirstlane_b32 s87, v62
    s_nop 0
    s_bfe_u32 s73, s87, 0x40002
    s_lshl_b32 s73, s73, 15
    s_and_b32 s74, s87, 3
    s_lshl_b32 s74, s74, 12
    s_add_u32 s73, s73, s74
    s_cmp_ge_u32 s87, 128
    s_cselect_b32 s73, 0x80000, s73
    s_add_u32 s70, s73, 0x4000
    s_cmp_ge_u32 s87, 64
    s_cbranch_scc1 L_rf14
    buffer_load_dwordx4 v[160:163], v1, s[36:39], s73 offen offset:0 nt
    buffer_load_dwordx4 v[164:167], v1, s[36:39], s73 offen offset:1024 nt
    buffer_load_dwordx4 v[168:171], v1, s[36:39], s73 offen offset:2048 nt
    buffer_load_dwordx4 v[172:175], v1, s[36:39], s73 offen offset:3072 nt
    buffer_load_dwordx4 v[176:179], v1, s[36:39], s70 offen offset:0 nt
    buffer_load_dwordx4 v[180:183], v1, s[36:39], s70 offen offset:1024 nt
    buffer_load_dwordx4 v[184:187], v1, s[36:39], s70 offen offset:2048 nt
    buffer_load_dwordx4 v[188:191], v1, s[36:39], s70 offen offset:3072 nt
    s_branch L_rf14_e
L_rf14:
    buffer_load_dwordx4 v[160:163], v2, s[40:43], s73 offen offset:0 nt
    buffer_load_dwordx4 v[164:167], v2, s[40:43], s73 offen offset:1024 nt
    buffer_load_dwordx4 v[168:171], v2, s[40:43], s73 offen offset:2048 nt
    buffer_load_dwordx4 v[172:175], v2, s[40:43], s73 offen offset:3072 nt
    buffer_load_dwordx4 v[176:179], v2, s[40:43], s70 offen offset:0 nt
    buffer_load_dwordx4 v[180:183], v2, s[40:43], s70 offen offset:1024 nt
    buffer_load_dwordx4 v[184:187], v2, s[40:43], s70 offen offset:2048 nt
    buffer_load_dwordx4 v[188:191], v2, s[40:43], s70 offen offset:3072 nt
L_rf14_e:
L_N3:
    s_cmp_ge_u32 s88, 128
    s_cbranch_scc1 L_sdone
    s_and_b32 s75, s88, 63
    s_lshl_b32 s75, s75, 6
    s_cmp_ge_u32 s88, 64
    s_cbranch_scc1 L_V4
    s_mov_b64 exec, 1
    ds_add_rtn_u32 v62, v60, v61 offset:2200
    s_mov_b64 exec, -1
    s_waitcnt vmcnt(46)
    v_mfma_f32_16x16x32_bf16 v[24:27], v[192:195], v[16:19], 0
    v_mfma_f32_16x16x32_bf16 v[28:31], v[196:199], v[20:23], 0
    s_waitcnt vmcnt(44)
    v_mfma_f32_16x16x32_bf16 v[32:35], v[200:203], v[16:19], 0
    v_mfma_f32_16x16x32_bf16 v[36:39], v[204:207], v[20:23], 0
    s_nop 4
    v_cndmask_b32_e64 v24, v28, v24, s[60:61]
    s_nop 1
    v_cndmask_b32_e64 v32, v36, v32, s[60:61]
    v_cndmask_b32_e64 v25, v29, v25, s[60:61]
    v_cndmask_b32_e64 v33, v37, v33, s[60:61]
    v_cndmask_b32_e64 v26, v30, v26, s[60:61]
    v_cndmask_b32_e64 v34, v38, v34, s[60:61]
    v_cndmask_b32_e64 v27, v31, v27, s[60:61]
    v_cndmask_b32_e64 v35, v39, v35, s[60:61]
    v_mov_b32_dpp v40, v24 quad_perm:[0,0,0,0] row_mask:0xf bank_mask:0xf
    v_mov_b32_dpp v41, v32 quad_perm:[0,0,0,0] row_mask:0xf bank_mask:0xf
    s_nop 0
    v_add_f32_dpp v40, v25, v40 quad_perm:[1,1,1,1] row_mask:0xf bank_mask:0xf
    v_add_f32_dpp v41, v33, v41 quad_perm:[1,1,1,1] row_mask:0xf bank_mask:0xf
    s_nop 0
    v_add_f32_dpp v40, v26, v40 quad_perm:[2,2,2,2] row_mask:0xf bank_mask:0xf
    v_add_f32_dpp v41, v34, v41 quad_perm:[2,2,2,2] row_mask:0xf bank_mask:0xf
    s_nop 0
    v_add_f32_dpp v40, v27, v40 quad_perm:[3,3,3,3] row_mask:0xf bank_mask:0xf
    v_add_f32_dpp v41, v35, v41 quad_perm:[3,3,3,3] row_mask:0xf bank_mask:0xf
    s_nop 0
    v_mov_b32_dpp v40, v40 row_ror:8 row_mask:0xa bank_mask:0xf
    v_mov_b32_dpp v41, v41 row_ror:8 row_mask:0xa bank_mask:0xf
    v_mov_b32 v56, v40
    v_mov_b32 v57, v41
    s_nop 0
    v_permlane16_swap_b32 v40, v56
    v_permlane16_swap_b32 v41, v57
    v_add_f32 v40, v40, v56
    v_add_f32 v41, v41, v57
    v_cvt_pk_bf16_f32 v44, v40, v41
    v_lshlrev_b32 v40, 16, v44
    v_and_b32 v41, 0xffff0000, v44
    v_max3_f32 v3, v40, v41, v3
    s_waitcnt vmcnt(42)
    v_mfma_f32_16x16x32_bf16 v[24:27], v[208:211], v[16:19], 0
    v_mfma_f32_16x16x32_bf16 v[28:31], v[212:215], v[20:23], 0
    s_waitcnt vmcnt(40)
    v_mfma_f32_16x16x32_bf16 v[32:35], v[216:219], v[16:19], 0
    v_mfma_f32_16x16x32_bf16 v[36:39], v[220:223], v[20:23], 0
    s_waitcnt lgkmcnt(0)
    v_readfirstlane_b32 s88, v62
    s_nop 0
    s_bfe_u32 s73, s88, 0x40002
    s_lshl_b32 s73, s73, 15
    s_and_b32 s74, s88, 3
    s_lshl_b32 s74, s74, 12
    s_add_u32 s73, s73, s74
    s_cmp_ge_u32 s88, 128
    s_cselect_b32 s73, 0x80000, s73
    s_add_u32 s70, s73, 0x4000
    s_cmp_ge_u32 s88, 64
    s_cbranch_scc1 L_rf15
    buffer_load_dwordx4 v[192:195], v1, s[36:39], s73 offen offset:0 nt
    buffer_load_dwordx4 v[196:199], v1, s[36:39], s73 offen offset:1024 nt
    buffer_load_dwordx4 v[200:203], v1, s[36:39], s73 offen offset:2048 nt
    buffer_load_dwordx4 v[204:207], v1, s[36:39], s73 offen offset:3072 nt
    buffer_load_dwordx4 v[208:211], v1, s[36:39], s70 offen offset:0 nt
    buffer_load_dwordx4 v[212:215], v1, s[36:39], s70 offen offset:1024 nt
    buffer_load_dwordx4 v[216:219], v1, s[36:39], s70 offen offset:2048 nt
    buffer_load_dwordx4 v[220:223], v1, s[36:39], s70 offen offset:3072 nt
    s_branch L_rf15_e
L_rf15:
    buffer_load_dwordx4 v[192:195], v2, s[40:43], s73 offen offset:0 nt
    buffer_load_dwordx4 v[196:199], v2, s[40:43], s73 offen offset:1024 nt
    buffer_load_dwordx4 v[200:203], v2, s[40:43], s73 offen offset:2048 nt
    buffer_load_dwordx4 v[204:207], v2, s[40:43], s73 offen offset:3072 nt
    buffer_load_dwordx4 v[208:211], v2, s[40:43], s70 offen offset:0 nt
    buffer_load_dwordx4 v[212:215], v2, s[40:43], s70 offen offset:1024 nt
    buffer_load_dwordx4 v[216:219], v2, s[40:43], s70 offen offset:2048 nt
    buffer_load_dwordx4 v[220:223], v2, s[40:43], s70 offen offset:3072 nt
L_rf15_e:
    v_cndmask_b32_e64 v24, v28, v24, s[60:61]
    v_cndmask_b32_e64 v32, v36, v32, s[60:61]
    v_cndmask_b32_e64 v25, v29, v25, s[60:61]
    v_cndmask_b32_e64 v33, v37, v33, s[60:61]
    v_cndmask_b32_e64 v26, v30, v26, s[60:61]
    v_cndmask_b32_e64 v34, v38, v34, s[60:61]
    v_cndmask_b32_e64 v27, v31, v27, s[60:61]
    v_cndmask_b32_e64 v35, v39, v35, s[60:61]
    v_mov_b32_dpp v40, v24 quad_perm:[0,0,0,0] row_mask:0xf bank_mask:0xf
    v_mov_b32_dpp v41, v32 quad_perm:[0,0,0,0] row_mask:0xf bank_mask:0xf
    s_nop 0
    v_add_f32_dpp v40, v25, v40 quad_perm:[1,1,1,1] row_mask:0xf bank_mask:0xf
    v_add_f32_dpp v41, v33, v41 quad_perm:[1,1,1,1] row_mask:0xf bank_mask:0xf
    s_nop 0
    v_add_f32_dpp v40, v26, v40 quad_perm:[2,2,2,2] row_mask:0xf bank_mask:0xf
    v_add_f32_dpp v41, v34, v41 quad_perm:[2,2,2,2] row_mask:0xf bank_mask:0xf
    s_nop 0
    v_add_f32_dpp v40, v27, v40 quad_perm:[3,3,3,3] row_mask:0xf bank_mask:0xf
    v_add_f32_dpp v41, v35, v41 quad_perm:[3,3,3,3] row_mask:0xf bank_mask:0xf
    s_nop 0
    v_mov_b32_dpp v40, v40 row_ror:8 row_mask:0xa bank_mask:0xf
    v_mov_b32_dpp v41, v41 row_ror:8 row_mask:0xa bank_mask:0xf
    v_mov_b32 v56, v40
    v_mov_b32 v57, v41
    s_nop 0
    v_permlane16_swap_b32 v40, v56
    v_permlane16_swap_b32 v41, v57
    v_add_f32 v40, v40, v56
    v_add_f32 v41, v41, v57
    v_cvt_pk_bf16_f32 v45, v40, v41
    v_lshlrev_b32 v40, 16, v45
    v_and_b32 v41, 0xffff0000, v45
    v_max3_f32 v3, v40, v41, v3
    v_add_u32 v56, s75, v7
    s_mov_b64 exec, s[76:77]
    ds_write_b64 v56, v[44:45] offset:20992
    s_mov_b64 exec, -1
    s_branch L_N4
L_V4:
    s_cmp_lg_u32 s72, 0
    s_cbranch_scc1 L_VT4
    v_max_f32_dpp v3, v3, v3 row_ror:8 row_mask:0xf bank_mask:0xf
    v_mov_b32 v57, v3
    s_nop 1
    v_permlane32_swap_b32 v3, v57
    v_max_f32 v3, v3, v57
    v_mov_b32 v57, v0
    s_mov_b64 exec, 0x11
    ds_max_f32 v57, v3 offset:2216
    s_waitcnt lgkmcnt(0)
    s_mov_b64 exec, 1
    ds_add_u32 v60, v61 offset:2212
    s_mov_b64 exec, -1
    s_mov_b32 s72, 1
    s_mov_b32 s74, 0
L_lw16:
    ds_read_b32 v62, v60 offset:2212
    s_add_u32 s74, s74, 1
    s_waitcnt lgkmcnt(0)
    v_readfirstlane_b32 s73, v62
    s_cmp_ge_u32 s74, 8388608
    s_nop 3
    s_cbranch_scc1 L_lw16_d
    s_cmp_ge_u32 s73, 4
    s_cbranch_scc0 L_lw16
L_lw16_d:
    v_bfe_u32 v57, v0, 2, 1
    v_lshlrev_b32 v57, 2, v57
    ds_read_b32 v6, v57 offset:2216
    s_waitcnt lgkmcnt(0)
    v_mul_f32 v6, s59, v6
    s_nop 2
L_VT4:
    v_add_u32 v56, s75, v5
    ds_read_b128 v[40:43], v56 offset:20992
    s_mov_b64 exec, 1
    ds_add_rtn_u32 v62, v60, v61 offset:2200
    s_mov_b64 exec, -1
    s_waitcnt lgkmcnt(1)
    v_lshlrev_b32 v24, 16, v40
    v_lshlrev_b32 v25, 16, v42
    v_and_b32 v26, 0xffff0000, v40
    v_and_b32 v27, 0xffff0000, v42
    v_lshlrev_b32 v28, 16, v41
    v_lshlrev_b32 v29, 16, v43
    v_and_b32 v30, 0xffff0000, v41
    v_and_b32 v31, 0xffff0000, v43
    v_fma_f32 v24, v24, s58, v6
    v_fma_f32 v25, v25, s58, v6
    v_fma_f32 v26, v26, s58, v6
    v_fma_f32 v27, v27, s58, v6
    v_fma_f32 v28, v28, s58, v6
    v_fma_f32 v29, v29, s58, v6
    v_fma_f32 v30, v30, s58, v6
    v_fma_f32 v31, v31, s58, v6
    v_exp_f32 v24, v24
    v_exp_f32 v25, v25
    v_exp_f32 v26, v26
    v_exp_f32 v27, v27
    v_exp_f32 v28, v28
    v_exp_f32 v29, v29
    v_exp_f32 v30, v30
    v_exp_f32 v31, v31
    v_cvt_pk_bf16_f32 v44, v24, v25
    v_cvt_pk_bf16_f32 v45, v26, v27
    v_cvt_pk_bf16_f32 v46, v28, v29
    v_cvt_pk_bf16_f32 v47, v30, v31
    v_add_f32 v24, v24, v25
    v_add_f32 v26, v26, v27
    v_add_f32 v28, v28, v29
    v_add_f32 v30, v30, v31
    v_add_f32 v24, v24, v26
    v_add_f32 v28, v28, v30
    v_add_f32 v4, v4, v24
    v_add_f32 v4, v4, v28
    s_waitcnt vmcnt(40)
    v_cndmask_b32_e64 v48, 0, v44, s[62:63]
    v_cndmask_b32_e64 v49, 0, v45, s[62:63]
    v_cndmask_b32_e64 v50, 0, v46, s[62:63]
    v_cndmask_b32_e64 v51, 0, v47, s[62:63]
    v_perm_b32 v24, v196, v192, s56
    v_perm_b32 v25, v204, v200, s56
    v_perm_b32 v26, v212, v208, s56
    v_perm_b32 v27, v220, v216, s56
    s_nop 1
    v_mfma_f32_16x16x32_bf16 v[8:11], v[48:51], v[24:27], v[8:11]
    v_perm_b32 v28, v198, v194, s56
    v_perm_b32 v29, v206, v202, s56
    v_perm_b32 v30, v214, v210, s56
    v_perm_b32 v31, v222, v218, s56
    s_nop 1
    v_mfma_f32_16x16x32_bf16 v[12:15], v[48:51], v[28:31], v[12:15]
    v_cndmask_b32_e64 v52, 0, v44, s[64:65]
    v_cndmask_b32_e64 v53, 0, v45, s[64:65]
    v_cndmask_b32_e64 v54, 0, v46, s[64:65]
    v_cndmask_b32_e64 v55, 0, v47, s[64:65]
    v_perm_b32 v32, v196, v192, s57
    v_perm_b32 v33, v204, v200, s57
    v_perm_b32 v34, v212, v208, s57
    v_perm_b32 v35, v220, v216, s57
    s_nop 1
    v_mfma_f32_16x16x32_bf16 v[8:11], v[52:55], v[32:35], v[8:11]
    v_perm_b32 v36, v198, v194, s57
    v_perm_b32 v37, v206, v202, s57
    v_perm_b32 v38, v214, v210, s57
    v_perm_b32 v39, v222, v218, s57
    s_nop 1
    v_mfma_f32_16x16x32_bf16 v[12:15], v[52:55], v[36:39], v[12:15]
    v_cndmask_b32_e64 v48, 0, v44, s[66:67]
    v_cndmask_b32_e64 v49, 0, v45, s[66:67]
    v_cndmask_b32_e64 v50, 0, v46, s[66:67]
    v_cndmask_b32_e64 v51, 0, v47, s[66:67]
    v_perm_b32 v24, v197, v193, s56
    v_perm_b32 v25, v205, v201, s56
    v_perm_b32 v26, v213, v209, s56
    v_perm_b32 v27, v221, v217, s56
    s_nop 1
    v_mfma_f32_16x16x32_bf16 v[8:11], v[48:51], v[24:27], v[8:11]
    v_perm_b32 v28, v199, v195, s56
    v_perm_b32 v29, v207, v203, s56
    v_perm_b32 v30, v215, v211, s56
    v_perm_b32 v31, v223, v219, s56
    s_nop 1
    v_mfma_f32_16x16x32_bf16 v[12:15], v[48:51], v[28:31], v[12:15]
    v_cndmask_b32_e64 v52, 0, v44, s[68:69]
    v_cndmask_b32_e64 v53, 0, v45, s[68:69]
    v_cndmask_b32_e64 v54, 0, v46, s[68:69]
    v_cndmask_b32_e64 v55, 0, v47, s[68:69]
    v_perm_b32 v32, v197, v193, s57
    v_perm_b32 v33, v205, v201, s57
    v_perm_b32 v34, v213, v209, s57
    v_perm_b32 v35, v221, v217, s57
    s_nop 1
    v_mfma_f32_16x16x32_bf16 v[8:11], v[52:55], v[32:35], v[8:11]
    v_perm_b32 v36, v199, v195, s57
    v_perm_b32 v37, v207, v203, s57
    v_perm_b32 v38, v215, v211, s57
    v_perm_b32 v39, v223, v219, s57
    s_nop 1
    v_mfma_f32_16x16x32_bf16 v[12:15], v[52:55], v[36:39], v[12:15]
    s_waitcnt lgkmcnt(0)
    v_readfirstlane_b32 s88, v62
    s_nop 0
    s_bfe_u32 s73, s88, 0x40002
    s_lshl_b32 s73, s73, 15
    s_and_b32 s74, s88, 3
    s_lshl_b32 s74, s74, 12
    s_add_u32 s73, s73, s74
    s_cmp_ge_u32 s88, 128
    s_cselect_b32 s73, 0x80000, s73
    s_add_u32 s70, s73, 0x4000
    s_cmp_ge_u32 s88, 64
    s_cbranch_scc1 L_rf17
    buffer_load_dwordx4 v[192:195], v1, s[36:39], s73 offen offset:0 nt
    buffer_load_dwordx4 v[196:199], v1, s[36:39], s73 offen offset:1024 nt
    buffer_load_dwordx4 v[200:203], v1, s[36:39], s73 offen offset:2048 nt
    buffer_load_dwordx4 v[204:207], v1, s[36:39], s73 offen offset:3072 nt
    buffer_load_dwordx4 v[208:211], v1, s[36:39], s70 offen offset:0 nt
    buffer_load_dwordx4 v[212:215], v1, s[36:39], s70 offen offset:1024 nt
    buffer_load_dwordx4 v[216:219], v1, s[36:39], s70 offen offset:2048 nt
    buffer_load_dwordx4 v[220:223], v1, s[36:39], s70 offen offset:3072 nt
    s_branch L_rf17_e
L_rf17:
    buffer_load_dwordx4 v[192:195], v2, s[40:43], s73 offen offset:0 nt
    buffer_load_dwordx4 v[196:199], v2, s[40:43], s73 offen offset:1024 nt
    buffer_load_dwordx4 v[200:203], v2, s[40:43], s73 offen offset:2048 nt
    buffer_load_dwordx4 v[204:207], v2, s[40:43], s73 offen offset:3072 nt
    buffer_load_dwordx4 v[208:211], v2, s[40:43], s70 offen offset:0 nt
    buffer_load_dwordx4 v[212:215], v2, s[40:43], s70 offen offset:1024 nt
    buffer_load_dwordx4 v[216:219], v2, s[40:43], s70 offen offset:2048 nt
    buffer_load_dwordx4 v[220:223], v2, s[40:43], s70 offen offset:3072 nt
L_rf17_e:
L_N4:
    s_cmp_ge_u32 s89, 128
    s_cbranch_scc1 L_sdone
    s_and_b32 s75, s89, 63
    s_lshl_b32 s75, s75, 6
    s_cmp_ge_u32 s89, 64
    s_cbranch_scc1 L_V5
    s_mov_b64 exec, 1
    ds_add_rtn_u32 v62, v60, v61 offset:2200
    s_mov_b64 exec, -1
    s_waitcnt vmcnt(46)
    v_mfma_f32_16x16x32_bf16 v[24:27], v[224:227], v[16:19], 0
    v_mfma_f32_16x16x32_bf16 v[28:31], v[228:231], v[20:23], 0
    s_waitcnt vmcnt(44)
    v_mfma_f32_16x16x32_bf16 v[32:35], v[232:235], v[16:19], 0
    v_mfma_f32_16x16x32_bf16 v[36:39], v[236:239], v[20:23], 0
    s_nop 4
    v_cndmask_b32_e64 v24, v28, v24, s[60:61]
    s_nop 1
    v_cndmask_b32_e64 v32, v36, v32, s[60:61]
    v_cndmask_b32_e64 v25, v29, v25, s[60:61]
    v_cndmask_b32_e64 v33, v37, v33, s[60:61]
    v_cndmask_b32_e64 v26, v30, v26, s[60:61]
    v_cndmask_b32_e64 v34, v38, v34, s[60:61]
    v_cndmask_b32_e64 v27, v31, v27, s[60:61]
    v_cndmask_b32_e64 v35, v39, v35, s[60:61]
    v_mov_b32_dpp v40, v24 quad_perm:[0,0,0,0] row_mask:0xf bank_mask:0xf
    v_mov_b32_dpp v41, v32 quad_perm:[0,0,0,0] row_mask:0xf bank_mask:0xf
    s_nop 0
    v_add_f32_dpp v40, v25, v40 quad_perm:[1,1,1,1] row_mask:0xf bank_mask:0xf
    v_add_f32_dpp v41, v33, v41 quad_perm:[1,1,1,1] row_mask:0xf bank_mask:0xf
    s_nop 0
    v_add_f32_dpp v40, v26, v40 quad_perm:[2,2,2,2] row_mask:0xf bank_mask:0xf
    v_add_f32_dpp v41, v34, v41 quad_perm:[2,2,2,2] row_mask:0xf bank_mask:0xf
    s_nop 0
    v_add_f32_dpp v40, v27, v40 quad_perm:[3,3,3,3] row_mask:0xf bank_mask:0xf
    v_add_f32_dpp v41, v35, v41 quad_perm:[3,3,3,3] row_mask:0xf bank_mask:0xf
    s_nop 0
    v_mov_b32_dpp v40, v40 row_ror:8 row_mask:0xa bank_mask:0xf
    v_mov_b32_dpp v41, v41 row_ror:8 row_mask:0xa bank_mask:0xf
    v_mov_b32 v56, v40
    v_mov_b32 v57, v41
    s_nop 0
    v_permlane16_swap_b32 v40, v56
    v_permlane16_swap_b32 v41, v57
    v_add_f32 v40, v40, v56
    v_add_f32 v41, v41, v57
    v_cvt_pk_bf16_f32 v44, v40, v41
    v_lshlrev_b32 v40, 16, v44
    v_and_b32 v41, 0xffff0000, v44
    v_max3_f32 v3, v40, v41, v3
    s_waitcnt vmcnt(42)
    v_mfma_f32_16x16x32_bf16 v[24:27], v[240:243], v[16:19], 0
    v_mfma_f32_16x16x32_bf16 v[28:31], v[244:247], v[20:23], 0
    s_waitcnt vmcnt(40)
    v_mfma_f32_16x16x32_bf16 v[32:35], v[248:251], v[16:19], 0
    v_mfma_f32_16x16x32_bf16 v[36:39], v[252:255], v[20:23], 0
    s_waitcnt lgkmcnt(0)
    v_readfirstlane_b32 s89, v62
    s_nop 0
    s_bfe_u32 s73, s89, 0x40002
    s_lshl_b32 s73, s73, 15
    s_and_b32 s74, s89, 3
    s_lshl_b32 s74, s74, 12
    s_add_u32 s73, s73, s74
    s_cmp_ge_u32 s89, 128
    s_cselect_b32 s73, 0x80000, s73
    s_add_u32 s70, s73, 0x4000
    s_cmp_ge_u32 s89, 64
    s_cbranch_scc1 L_rf18
    buffer_load_dwordx4 v[224:227], v1, s[36:39], s73 offen offset:0 nt
    buffer_load_dwordx4 v[228:231], v1, s[36:39], s73 offen offset:1024 nt
    buffer_load_dwordx4 v[232:235], v1, s[36:39], s73 offen offset:2048 nt
    buffer_load_dwordx4 v[236:239], v1, s[36:39], s73 offen offset:3072 nt
    buffer_load_dwordx4 v[240:243], v1, s[36:39], s70 offen offset:0 nt
    buffer_load_dwordx4 v[244:247], v1, s[36:39], s70 offen offset:1024 nt
    buffer_load_dwordx4 v[248:251], v1, s[36:39], s70 offen offset:2048 nt
    buffer_load_dwordx4 v[252:255], v1, s[36:39], s70 offen offset:3072 nt
    s_branch L_rf18_e
L_rf18:
    buffer_load_dwordx4 v[224:227], v2, s[40:43], s73 offen offset:0 nt
    buffer_load_dwordx4 v[228:231], v2, s[40:43], s73 offen offset:1024 nt
    buffer_load_dwordx4 v[232:235], v2, s[40:43], s73 offen offset:2048 nt
    buffer_load_dwordx4 v[236:239], v2, s[40:43], s73 offen offset:3072 nt
    buffer_load_dwordx4 v[240:243], v2, s[40:43], s70 offen offset:0 nt
    buffer_load_dwordx4 v[244:247], v2, s[40:43], s70 offen offset:1024 nt
    buffer_load_dwordx4 v[248:251], v2, s[40:43], s70 offen offset:2048 nt
    buffer_load_dwordx4 v[252:255], v2, s[40:43], s70 offen offset:3072 nt
L_rf18_e:
    v_cndmask_b32_e64 v24, v28, v24, s[60:61]
    v_cndmask_b32_e64 v32, v36, v32, s[60:61]
    v_cndmask_b32_e64 v25, v29, v25, s[60:61]
    v_cndmask_b32_e64 v33, v37, v33, s[60:61]
    v_cndmask_b32_e64 v26, v30, v26, s[60:61]
    v_cndmask_b32_e64 v34, v38, v34, s[60:61]
    v_cndmask_b32_e64 v27, v31, v27, s[60:61]
    v_cndmask_b32_e64 v35, v39, v35, s[60:61]
    v_mov_b32_dpp v40, v24 quad_perm:[0,0,0,0] row_mask:0xf bank_mask:0xf
    v_mov_b32_dpp v41, v32 quad_perm:[0,0,0,0] row_mask:0xf bank_mask:0xf
    s_nop 0
    v_add_f32_dpp v40, v25, v40 quad_perm:[1,1,1,1] row_mask:0xf bank_mask:0xf
    v_add_f32_dpp v41, v33, v41 quad_perm:[1,1,1,1] row_mask:0xf bank_mask:0xf
    s_nop 0
    v_add_f32_dpp v40, v26, v40 quad_perm:[2,2,2,2] row_mask:0xf bank_mask:0xf
    v_add_f32_dpp v41, v34, v41 quad_perm:[2,2,2,2] row_mask:0xf bank_mask:0xf
    s_nop 0
    v_add_f32_dpp v40, v27, v40 quad_perm:[3,3,3,3] row_mask:0xf bank_mask:0xf
    v_add_f32_dpp v41, v35, v41 quad_perm:[3,3,3,3] row_mask:0xf bank_mask:0xf
    s_nop 0
    v_mov_b32_dpp v40, v40 row_ror:8 row_mask:0xa bank_mask:0xf
    v_mov_b32_dpp v41, v41 row_ror:8 row_mask:0xa bank_mask:0xf
    v_mov_b32 v56, v40
    v_mov_b32 v57, v41
    s_nop 0
    v_permlane16_swap_b32 v40, v56
    v_permlane16_swap_b32 v41, v57
    v_add_f32 v40, v40, v56
    v_add_f32 v41, v41, v57
    v_cvt_pk_bf16_f32 v45, v40, v41
    v_lshlrev_b32 v40, 16, v45
    v_and_b32 v41, 0xffff0000, v45
    v_max3_f32 v3, v40, v41, v3
    v_add_u32 v56, s75, v7
    s_mov_b64 exec, s[76:77]
    ds_write_b64 v56, v[44:45] offset:20992
    s_mov_b64 exec, -1
    s_branch L_N5
L_V5:
    s_cmp_lg_u32 s72, 0
    s_cbranch_scc1 L_VT5
    v_max_f32_dpp v3, v3, v3 row_ror:8 row_mask:0xf bank_mask:0xf
    v_mov_b32 v57, v3
    s_nop 1
    v_permlane32_swap_b32 v3, v57
    v_max_f32 v3, v3, v57
    v_mov_b32 v57, v0
    s_mov_b64 exec, 0x11
    ds_max_f32 v57, v3 offset:2216
    s_waitcnt lgkmcnt(0)
    s_mov_b64 exec, 1
    ds_add_u32 v60, v61 offset:2212
    s_mov_b64 exec, -1
    s_mov_b32 s72, 1
    s_mov_b32 s74, 0
L_lw19:
    ds_read_b32 v62, v60 offset:2212
    s_add_u32 s74, s74, 1
    s_waitcnt lgkmcnt(0)
    v_readfirstlane_b32 s73, v62
    s_cmp_ge_u32 s74, 8388608
    s_nop 3
    s_cbranch_scc1 L_lw19_d
    s_cmp_ge_u32 s73, 4
    s_cbranch_scc0 L_lw19
L_lw19_d:
    v_bfe_u32 v57, v0, 2, 1
    v_lshlrev_b32 v57, 2, v57
    ds_read_b32 v6, v57 offset:2216
    s_waitcnt lgkmcnt(0)
    v_mul_f32 v6, s59, v6
    s_nop 2
L_VT5:
    v_add_u32 v56, s75, v5
    ds_read_b128 v[40:43], v56 offset:20992
    s_mov_b64 exec, 1
    ds_add_rtn_u32 v62, v60, v61 offset:2200
    s_mov_b64 exec, -1
    s_waitcnt lgkmcnt(1)
    v_lshlrev_b32 v24, 16, v40
    v_lshlrev_b32 v25, 16, v42
    v_and_b32 v26, 0xffff0000, v40
    v_and_b32 v27, 0xffff0000, v42
    v_lshlrev_b32 v28, 16, v41
    v_lshlrev_b32 v29, 16, v43
    v_and_b32 v30, 0xffff0000, v41
    v_and_b32 v31, 0xffff0000, v43
    v_fma_f32 v24, v24, s58, v6
    v_fma_f32 v25, v25, s58, v6
    v_fma_f32 v26, v26, s58, v6
    v_fma_f32 v27, v27, s58, v6
    v_fma_f32 v28, v28, s58, v6
    v_fma_f32 v29, v29, s58, v6
    v_fma_f32 v30, v30, s58, v6
    v_fma_f32 v31, v31, s58, v6
    v_exp_f32 v24, v24
    v_exp_f32 v25, v25
    v_exp_f32 v26, v26
    v_exp_f32 v27, v27
    v_exp_f32 v28, v28
    v_exp_f32 v29, v29
    v_exp_f32 v30, v30
    v_exp_f32 v31, v31
    v_cvt_pk_bf16_f32 v44, v24, v25
    v_cvt_pk_bf16_f32 v45, v26, v27
    v_cvt_pk_bf16_f32 v46, v28, v29
    v_cvt_pk_bf16_f32 v47, v30, v31
    v_add_f32 v24, v24, v25
    v_add_f32 v26, v26, v27
    v_add_f32 v28, v28, v29
    v_add_f32 v30, v30, v31
    v_add_f32 v24, v24, v26
    v_add_f32 v28, v28, v30
    v_add_f32 v4, v4, v24
    v_add_f32 v4, v4, v28
    s_waitcnt vmcnt(40)
    v_cndmask_b32_e64 v48, 0, v44, s[62:63]
    v_cndmask_b32_e64 v49, 0, v45, s[62:63]
    v_cndmask_b32_e64 v50, 0, v46, s[62:63]
    v_cndmask_b32_e64 v51, 0, v47, s[62:63]
    v_perm_b32 v24, v228, v224, s56
    v_perm_b32 v25, v236, v232, s56
    v_perm_b32 v26, v244, v240, s56
    v_perm_b32 v27, v252, v248, s56
    s_nop 1
    v_mfma_f32_16x16x32_bf16 v[8:11], v[48:51], v[24:27], v[8:11]
    v_perm_b32 v28, v230, v226, s56
    v_perm_b32 v29, v238, v234, s56
    v_perm_b32 v30, v246, v242, s56
    v_perm_b32 v31, v254, v250, s56
    s_nop 1
    v_mfma_f32_16x16x32_bf16 v[12:15], v[48:51], v[28:31], v[12:15]
    v_cndmask_b32_e64 v52, 0, v44, s[64:65]
    v_cndmask_b32_e64 v53, 0, v45, s[64:65]
    v_cndmask_b32_e64 v54, 0, v46, s[64:65]
    v_cndmask_b32_e64 v55, 0, v47, s[64:65]
    v_perm_b32 v32, v228, v224, s57
    v_perm_b32 v33, v236, v232, s57
    v_perm_b32 v34, v244, v240, s57
    v_perm_b32 v35, v252, v248, s57
    s_nop 1
    v_mfma_f32_16x16x32_bf16 v[8:11], v[52:55], v[32:35], v[8:11]
    v_perm_b32 v36, v230, v226, s57
    v_perm_b32 v37, v238, v234, s57
    v_perm_b32 v38, v246, v242, s57
    v_perm_b32 v39, v254, v250, s57
    s_nop 1
    v_mfma_f32_16x16x32_bf16 v[12:15], v[52:55], v[36:39], v[12:15]
    v_cndmask_b32_e64 v48, 0, v44, s[66:67]
    v_cndmask_b32_e64 v49, 0, v45, s[66:67]
    v_cndmask_b32_e64 v50, 0, v46, s[66:67]
    v_cndmask_b32_e64 v51, 0, v47, s[66:67]
    v_perm_b32 v24, v229, v225, s56
    v_perm_b32 v25, v237, v233, s56
    v_perm_b32 v26, v245, v241, s56
    v_perm_b32 v27, v253, v249, s56
    s_nop 1
    v_mfma_f32_16x16x32_bf16 v[8:11], v[48:51], v[24:27], v[8:11]
    v_perm_b32 v28, v231, v227, s56
    v_perm_b32 v29, v239, v235, s56
    v_perm_b32 v30, v247, v243, s56
    v_perm_b32 v31, v255, v251, s56
    s_nop 1
    v_mfma_f32_16x16x32_bf16 v[12:15], v[48:51], v[28:31], v[12:15]
    v_cndmask_b32_e64 v52, 0, v44, s[68:69]
    v_cndmask_b32_e64 v53, 0, v45, s[68:69]
    v_cndmask_b32_e64 v54, 0, v46, s[68:69]
    v_cndmask_b32_e64 v55, 0, v47, s[68:69]
    v_perm_b32 v32, v229, v225, s57
    v_perm_b32 v33, v237, v233, s57
    v_perm_b32 v34, v245, v241, s57
    v_perm_b32 v35, v253, v249, s57
    s_nop 1
    v_mfma_f32_16x16x32_bf16 v[8:11], v[52:55], v[32:35], v[8:11]
    v_perm_b32 v36, v231, v227, s57
    v_perm_b32 v37, v239, v235, s57
    v_perm_b32 v38, v247, v243, s57
    v_perm_b32 v39, v255, v251, s57
    s_nop 1
    v_mfma_f32_16x16x32_bf16 v[12:15], v[52:55], v[36:39], v[12:15]
    s_waitcnt lgkmcnt(0)
    v_readfirstlane_b32 s89, v62
    s_nop 0
    s_bfe_u32 s73, s89, 0x40002
    s_lshl_b32 s73, s73, 15
    s_and_b32 s74, s89, 3
    s_lshl_b32 s74, s74, 12
    s_add_u32 s73, s73, s74
    s_cmp_ge_u32 s89, 128
    s_cselect_b32 s73, 0x80000, s73
    s_add_u32 s70, s73, 0x4000
    s_cmp_ge_u32 s89, 64
    s_cbranch_scc1 L_rf20
    buffer_load_dwordx4 v[224:227], v1, s[36:39], s73 offen offset:0 nt
    buffer_load_dwordx4 v[228:231], v1, s[36:39], s73 offen offset:1024 nt
    buffer_load_dwordx4 v[232:235], v1, s[36:39], s73 offen offset:2048 nt
    buffer_load_dwordx4 v[236:239], v1, s[36:39], s73 offen offset:3072 nt
    buffer_load_dwordx4 v[240:243], v1, s[36:39], s70 offen offset:0 nt
    buffer_load_dwordx4 v[244:247], v1, s[36:39], s70 offen offset:1024 nt
    buffer_load_dwordx4 v[248:251], v1, s[36:39], s70 offen offset:2048 nt
    buffer_load_dwordx4 v[252:255], v1, s[36:39], s70 offen offset:3072 nt
    s_branch L_rf20_e
L_rf20:
    buffer_load_dwordx4 v[224:227], v2, s[40:43], s73 offen offset:0 nt
    buffer_load_dwordx4 v[228:231], v2, s[40:43], s73 offen offset:1024 nt
    buffer_load_dwordx4 v[232:235], v2, s[40:43], s73 offen offset:2048 nt
    buffer_load_dwordx4 v[236:239], v2, s[40:43], s73 offen offset:3072 nt
    buffer_load_dwordx4 v[240:243], v2, s[40:43], s70 offen offset:0 nt
    buffer_load_dwordx4 v[244:247], v2, s[40:43], s70 offen offset:1024 nt
    buffer_load_dwordx4 v[248:251], v2, s[40:43], s70 offen offset:2048 nt
    buffer_load_dwordx4 v[252:255], v2, s[40:43], s70 offen offset:3072 nt
L_rf20_e:
L_N5:
    s_branch L_loop
L_sdone:
    s_cmp_lg_u32 s72, 0
    s_cbranch_scc1 L_sd2
    v_max_f32_dpp v3, v3, v3 row_ror:8 row_mask:0xf bank_mask:0xf
    v_mov_b32 v57, v3
    s_nop 1
    v_permlane32_swap_b32 v3, v57
    v_max_f32 v3, v3, v57
    v_mov_b32 v57, v0
    s_mov_b64 exec, 0x11
    ds_max_f32 v57, v3 offset:2216
    s_waitcnt lgkmcnt(0)
    s_mov_b64 exec, 1
    ds_add_u32 v60, v61 offset:2212
    s_mov_b64 exec, -1
    s_mov_b32 s72, 1
L_sd2:
    s_lshl_b32 s73, s28, 11
    v_lshlrev_b32 v57, 5, v0
    v_add_u32 v57, s73, v57
    ds_write_b128 v57, v[8:11] offset:4608
    ds_write_b128 v57, v[12:15] offset:4624
    v_mov_b32 v56, v4
    s_lshl_b32 s73, s28, 4
    v_lshlrev_b32 v57, 1, v0
    v_permlane32_swap_b32 v4, v56
    v_add_u32 v57, s73, v57
    v_add_f32 v59, v4, v56
    s_mov_b64 exec, 0x11
    ds_write_b32 v57, v59 offset:2052
    s_mov_b64 exec, -1
    s_bfe_u32 s32, s2, 0x20003
    s_lshl_b32 s33, s31, 3
    s_add_u32 s33, s33, s30
    s_branch L_combine
L_hrest:
    s_cmp_lg_u32 s34, 1
    s_cbranch_scc1 L_noffn
    s_mov_b32 s40, s16
    s_mov_b32 s41, s17
    s_mov_b32 s42, 0x188000
    s_mov_b32 s43, 0x20000
    s_mov_b32 s48, s18
    s_mov_b32 s49, s19
    s_mov_b32 s50, 0x188000
    s_mov_b32 s51, 0x20000
    v_lshrrev_b32 v3, 2, v0
    v_mul_u32_u24 v3, 0xe00, v3
    v_and_b32 v4, 3, v0
    v_lshl_add_u32 v3, v4, 4, v3
    s_mul_i32 s73, s33, 56
    v_add_u32 v3, s73, v3
    v_lshlrev_b32 v6, 4, v0
    s_mul_i32 s73, s32, 896
    buffer_load_dwordx4 v[16:19], v6, s[36:39], s73 offen
    s_mov_b32 s75, 0
    buffer_load_dwordx4 v[24:27], v3, s[40:43], s75 offen
    s_add_u32 s75, s75, 0xe000
    buffer_load_dwordx4 v[28:31], v3, s[40:43], s75 offen
    s_add_u32 s75, s75, 0xe000
    buffer_load_dwordx4 v[32:35], v3, s[40:43], s75 offen
    s_add_u32 s75, s75, 0xe000
    buffer_load_dwordx4 v[36:39], v3, s[40:43], s75 offen
    s_add_u32 s75, s75, 0xe000
    buffer_load_dwordx4 v[40:43], v3, s[40:43], s75 offen
    s_add_u32 s75, s75, 0xe000
    buffer_load_dwordx4 v[44:47], v3, s[40:43], s75 offen
    s_add_u32 s75, s75, 0xe000
    buffer_load_dwordx4 v[48:51], v3, s[40:43], s75 offen
    s_add_u32 s75, s75, 0xe000
    buffer_load_dwordx4 v[52:55], v3, s[40:43], s75 offen
    s_add_u32 s75, s75, 0xe000
    buffer_load_dwordx4 v[56:59], v3, s[40:43], s75 offen
    s_add_u32 s75, s75, 0xe000
    buffer_load_dwordx4 v[60:63], v3, s[40:43], s75 offen
    s_add_u32 s75, s75, 0xe000
    buffer_load_dwordx4 v[64:67], v3, s[40:43], s75 offen
    s_add_u32 s75, s75, 0xe000
    buffer_load_dwordx4 v[68:71], v3, s[40:43], s75 offen
    s_add_u32 s75, s75, 0xe000
    buffer_load_dwordx4 v[72:75], v3, s[40:43], s75 offen
    s_add_u32 s75, s75, 0xe000
    buffer_load_dwordx4 v[76:79], v3, s[40:43], s75 offen
    s_add_u32 s75, s75, 0xe000
    s_mul_i32 s76, s33, 28*896
    buffer_load_dwordx4 v[80:83], v6, s[48:51], s76 offen offset:0
    buffer_load_dwordx4 v[84:87], v6, s[48:51], s76 offen offset:896
    buffer_load_dwordx4 v[88:91], v6, s[48:51], s76 offen offset:1792
    buffer_load_dwordx4 v[92:95], v6, s[48:51], s76 offen offset:2688
    s_add_u32 s76, s76, 3584
    buffer_load_dwordx4 v[96:99], v6, s[48:51], s76 offen offset:0
    buffer_load_dwordx4 v[100:103], v6, s[48:51], s76 offen offset:896
    buffer_load_dwordx4 v[104:107], v6, s[48:51], s76 offen offset:1792
    buffer_load_dwordx4 v[108:111], v6, s[48:51], s76 offen offset:2688
    s_add_u32 s76, s76, 3584
    buffer_load_dwordx4 v[112:115], v6, s[48:51], s76 offen offset:0
    buffer_load_dwordx4 v[116:119], v6, s[48:51], s76 offen offset:896
    buffer_load_dwordx4 v[120:123], v6, s[48:51], s76 offen offset:1792
    buffer_load_dwordx4 v[124:127], v6, s[48:51], s76 offen offset:2688
    s_add_u32 s76, s76, 3584
    buffer_load_dwordx4 v[128:131], v6, s[48:51], s76 offen offset:0
    buffer_load_dwordx4 v[132:135], v6, s[48:51], s76 offen offset:896
    buffer_load_dwordx4 v[136:139], v6, s[48:51], s76 offen offset:1792
    buffer_load_dwordx4 v[140:143], v6, s[48:51], s76 offen offset:2688
    s_add_u32 s76, s76, 3584
    buffer_load_dwordx4 v[144:147], v6, s[48:51], s76 offen offset:0
    buffer_load_dwordx4 v[148:151], v6, s[48:51], s76 offen offset:896
    buffer_load_dwordx4 v[152:155], v6, s[48:51], s76 offen offset:1792
    buffer_load_dwordx4 v[156:159], v6, s[48:51], s76 offen offset:2688
    s_add_u32 s76, s76, 3584
    buffer_load_dwordx4 v[160:163], v6, s[48:51], s76 offen offset:0
    buffer_load_dwordx4 v[164:167], v6, s[48:51], s76 offen offset:896
    buffer_load_dwordx4 v[168:171], v6, s[48:51], s76 offen offset:1792
    buffer_load_dwordx4 v[172:175], v6, s[48:51], s76 offen offset:2688
    s_add_u32 s76, s76, 3584
    buffer_load_dwordx4 v[176:179], v6, s[48:51], s76 offen offset:0
    buffer_load_dwordx4 v[180:183], v6, s[48:51], s76 offen offset:896
    buffer_load_dwordx4 v[184:187], v6, s[48:51], s76 offen offset:1792
    buffer_load_dwordx4 v[188:191], v6, s[48:51], s76 offen offset:2688
    s_setprio 0
    v_lshrrev_b32 v7, 2, v1
    v_lshl_add_u32 v7, v2, 3, v7
    v_lshlrev_b32 v7, 6, v7
    v_and_b32 v8, 3, v1
    v_lshl_add_u32 v7, v8, 3, v7
    v_lshlrev_b32 v5, 4, v2
    s_waitcnt vmcnt(42)
    ds_write_b128 v6, v[16:19] offset:19968
    s_waitcnt vmcnt(28)
    ds_write_b128 v6, v[24:27] offset:12800
    ds_write_b128 v6, v[28:31] offset:13824
    ds_write_b128 v6, v[32:35] offset:14848
    ds_write_b128 v6, v[36:39] offset:15872
    ds_write_b128 v6, v[40:43] offset:16896
    ds_write_b128 v6, v[44:47] offset:17920
    s_waitcnt lgkmcnt(0)
    ds_read_b128 v[16:19], v5 offset:19968
    ds_read_b64_tr_b16 v[20:21], v7 offset:12800
    ds_read_b64_tr_b16 v[22:23], v7 offset:13056
    s_waitcnt lgkmcnt(0)
    v_mfma_f32_16x16x32_bf16 v[8:11], v[16:19], v[20:23], 0
    ds_read_b64_tr_b16 v[20:21], v7 offset:12832
    ds_read_b64_tr_b16 v[22:23], v7 offset:13088
    s_waitcnt lgkmcnt(0)
    v_mfma_f32_16x16x32_bf16 v[12:15], v[16:19], v[20:23], 0
    ds_read_b128 v[16:19], v5 offset:20032
    ds_read_b64_tr_b16 v[20:21], v7 offset:14848
    ds_read_b64_tr_b16 v[22:23], v7 offset:15104
    s_waitcnt lgkmcnt(0)
    v_mfma_f32_16x16x32_bf16 v[8:11], v[16:19], v[20:23], v[8:11]
    ds_read_b64_tr_b16 v[20:21], v7 offset:14880
    ds_read_b64_tr_b16 v[22:23], v7 offset:15136
    s_waitcnt lgkmcnt(0)
    v_mfma_f32_16x16x32_bf16 v[12:15], v[16:19], v[20:23], v[12:15]
    ds_read_b128 v[16:19], v5 offset:20096
    ds_read_b64_tr_b16 v[20:21], v7 offset:16896
    ds_read_b64_tr_b16 v[22:23], v7 offset:17152
    s_waitcnt lgkmcnt(0)
    v_mfma_f32_16x16x32_bf16 v[8:11], v[16:19], v[20:23], v[8:11]
    ds_read_b64_tr_b16 v[20:21], v7 offset:16928
    ds_read_b64_tr_b16 v[22:23], v7 offset:17184
    s_waitcnt lgkmcnt(0)
    v_mfma_f32_16x16x32_bf16 v[12:15], v[16:19], v[20:23], v[12:15]
    ds_write_b128 v6, v[48:51] offset:12800
    ds_write_b128 v6, v[52:55] offset:13824
    ds_write_b128 v6, v[56:59] offset:14848
    ds_write_b128 v6, v[60:63] offset:15872
    ds_write_b128 v6, v[64:67] offset:16896
    ds_write_b128 v6, v[68:71] offset:17920
    s_waitcnt lgkmcnt(0)
    ds_read_b128 v[16:19], v5 offset:20160
    ds_read_b64_tr_b16 v[20:21], v7 offset:12800
    ds_read_b64_tr_b16 v[22:23], v7 offset:13056
    s_waitcnt lgkmcnt(0)
    v_mfma_f32_16x16x32_bf16 v[8:11], v[16:19], v[20:23], v[8:11]
    ds_read_b64_tr_b16 v[20:21], v7 offset:12832
    ds_read_b64_tr_b16 v[22:23], v7 offset:13088
    s_waitcnt lgkmcnt(0)
    v_mfma_f32_16x16x32_bf16 v[12:15], v[16:19], v[20:23], v[12:15]
    ds_read_b128 v[16:19], v5 offset:20224
    ds_read_b64_tr_b16 v[20:21], v7 offset:14848
    ds_read_b64_tr_b16 v[22:23], v7 offset:15104
    s_waitcnt lgkmcnt(0)
    v_mfma_f32_16x16x32_bf16 v[8:11], v[16:19], v[20:23], v[8:11]
    ds_read_b64_tr_b16 v[20:21], v7 offset:14880
    ds_read_b64_tr_b16 v[22:23], v7 offset:15136
    s_waitcnt lgkmcnt(0)
    v_mfma_f32_16x16x32_bf16 v[12:15], v[16:19], v[20:23], v[12:15]
    ds_read_b128 v[16:19], v5 offset:20288
    ds_read_b64_tr_b16 v[20:21], v7 offset:16896
    ds_read_b64_tr_b16 v[22:23], v7 offset:17152
    s_waitcnt lgkmcnt(0)
    v_mfma_f32_16x16x32_bf16 v[8:11], v[16:19], v[20:23], v[8:11]
    ds_read_b64_tr_b16 v[20:21], v7 offset:16928
    ds_read_b64_tr_b16 v[22:23], v7 offset:17184
    s_waitcnt lgkmcnt(0)
    v_mfma_f32_16x16x32_bf16 v[12:15], v[16:19], v[20:23], v[12:15]
    ds_write_b128 v6, v[72:75] offset:12800
    ds_write_b128 v6, v[76:79] offset:13824
    s_waitcnt lgkmcnt(0)
    ds_read_b128 v[16:19], v5 offset:20352
    ds_read_b64_tr_b16 v[20:21], v7 offset:12800
    ds_read_b64_tr_b16 v[22:23], v7 offset:13056
    s_waitcnt lgkmcnt(0)
    v_mfma_f32_16x16x32_bf16 v[8:11], v[16:19], v[20:23], v[8:11]
    ds_read_b64_tr_b16 v[20:21], v7 offset:12832
    ds_read_b64_tr_b16 v[22:23], v7 offset:13088
    s_waitcnt lgkmcnt(0)
    v_mfma_f32_16x16x32_bf16 v[12:15], v[16:19], v[20:23], v[12:15]
    s_setprio 3
    buffer_load_dwordx4 v[24:27], v3, s[40:43], s75 offen
    s_add_u32 s75, s75, 0xe000
    buffer_load_dwordx4 v[28:31], v3, s[40:43], s75 offen
    s_add_u32 s75, s75, 0xe000
    buffer_load_dwordx4 v[32:35], v3, s[40:43], s75 offen
    s_add_u32 s75, s75, 0xe000
    buffer_load_dwordx4 v[36:39], v3, s[40:43], s75 offen
    s_add_u32 s75, s75, 0xe000
    buffer_load_dwordx4 v[40:43], v3, s[40:43], s75 offen
    s_add_u32 s75, s75, 0xe000
    buffer_load_dwordx4 v[44:47], v3, s[40:43], s75 offen
    s_add_u32 s75, s75, 0xe000
    buffer_load_dwordx4 v[48:51], v3, s[40:43], s75 offen
    s_add_u32 s75, s75, 0xe000
    buffer_load_dwordx4 v[52:55], v3, s[40:43], s75 offen
    s_add_u32 s75, s75, 0xe000
    buffer_load_dwordx4 v[56:59], v3, s[40:43], s75 offen
    s_add_u32 s75, s75, 0xe000
    buffer_load_dwordx4 v[60:63], v3, s[40:43], s75 offen
    s_add_u32 s75, s75, 0xe000
    buffer_load_dwordx4 v[64:67], v3, s[40:43], s75 offen
    s_add_u32 s75, s75, 0xe000
    buffer_load_dwordx4 v[68:71], v3, s[40:43], s75 offen
    s_add_u32 s75, s75, 0xe000
    buffer_load_dwordx4 v[72:75], v3, s[40:43], s75 offen
    s_add_u32 s75, s75, 0xe000
    buffer_load_dwordx4 v[76:79], v3, s[40:43], s75 offen
    s_add_u32 s75, s75, 0xe000
    s_setprio 0
    s_waitcnt vmcnt(0)
    ds_write_b128 v6, v[24:27] offset:12800
    ds_write_b128 v6, v[28:31] offset:13824
    ds_write_b128 v6, v[32:35] offset:14848
    ds_write_b128 v6, v[36:39] offset:15872
    ds_write_b128 v6, v[40:43] offset:16896
    ds_write_b128 v6, v[44:47] offset:17920
    s_waitcnt lgkmcnt(0)
    ds_read_b128 v[16:19], v5 offset:20416
    ds_read_b64_tr_b16 v[20:21], v7 offset:12800
    ds_read_b64_tr_b16 v[22:23], v7 offset:13056
    s_waitcnt lgkmcnt(0)
    v_mfma_f32_16x16x32_bf16 v[8:11], v[16:19], v[20:23], v[8:11]
    ds_read_b64_tr_b16 v[20:21], v7 offset:12832
    ds_read_b64_tr_b16 v[22:23], v7 offset:13088
    s_waitcnt lgkmcnt(0)
    v_mfma_f32_16x16x32_bf16 v[12:15], v[16:19], v[20:23], v[12:15]
    ds_read_b128 v[16:19], v5 offset:20480
    ds_read_b64_tr_b16 v[20:21], v7 offset:14848
    ds_read_b64_tr_b16 v[22:23], v7 offset:15104
    s_waitcnt lgkmcnt(0)
    v_mfma_f32_16x16x32_bf16 v[8:11], v[16:19], v[20:23], v[8:11]
    ds_read_b64_tr_b16 v[20:21], v7 offset:14880
    ds_read_b64_tr_b16 v[22:23], v7 offset:15136
    s_waitcnt lgkmcnt(0)
    v_mfma_f32_16x16x32_bf16 v[12:15], v[16:19], v[20:23], v[12:15]
    ds_read_b128 v[16:19], v5 offset:20544
    ds_read_b64_tr_b16 v[20:21], v7 offset:16896
    ds_read_b64_tr_b16 v[22:23], v7 offset:17152
    s_waitcnt lgkmcnt(0)
    v_mfma_f32_16x16x32_bf16 v[8:11], v[16:19], v[20:23], v[8:11]
    ds_read_b64_tr_b16 v[20:21], v7 offset:16928
    ds_read_b64_tr_b16 v[22:23], v7 offset:17184
    s_waitcnt lgkmcnt(0)
    v_mfma_f32_16x16x32_bf16 v[12:15], v[16:19], v[20:23], v[12:15]
    ds_write_b128 v6, v[48:51] offset:12800
    ds_write_b128 v6, v[52:55] offset:13824
    ds_write_b128 v6, v[56:59] offset:14848
    ds_write_b128 v6, v[60:63] offset:15872
    ds_write_b128 v6, v[64:67] offset:16896
    ds_write_b128 v6, v[68:71] offset:17920
    s_waitcnt lgkmcnt(0)
    ds_read_b128 v[16:19], v5 offset:20608
    ds_read_b64_tr_b16 v[20:21], v7 offset:12800
    ds_read_b64_tr_b16 v[22:23], v7 offset:13056
    s_waitcnt lgkmcnt(0)
    v_mfma_f32_16x16x32_bf16 v[8:11], v[16:19], v[20:23], v[8:11]
    ds_read_b64_tr_b16 v[20:21], v7 offset:12832
    ds_read_b64_tr_b16 v[22:23], v7 offset:13088
    s_waitcnt lgkmcnt(0)
    v_mfma_f32_16x16x32_bf16 v[12:15], v[16:19], v[20:23], v[12:15]
    ds_read_b128 v[16:19], v5 offset:20672
    ds_read_b64_tr_b16 v[20:21], v7 offset:14848
    ds_read_b64_tr_b16 v[22:23], v7 offset:15104
    s_waitcnt lgkmcnt(0)
    v_mfma_f32_16x16x32_bf16 v[8:11], v[16:19], v[20:23], v[8:11]
    ds_read_b64_tr_b16 v[20:21], v7 offset:14880
    ds_read_b64_tr_b16 v[22:23], v7 offset:15136
    s_waitcnt lgkmcnt(0)
    v_mfma_f32_16x16x32_bf16 v[12:15], v[16:19], v[20:23], v[12:15]
    ds_read_b128 v[16:19], v5 offset:20736
    ds_read_b64_tr_b16 v[20:21], v7 offset:16896
    ds_read_b64_tr_b16 v[22:23], v7 offset:17152
    s_waitcnt lgkmcnt(0)
    v_mfma_f32_16x16x32_bf16 v[8:11], v[16:19], v[20:23], v[8:11]
    ds_read_b64_tr_b16 v[20:21], v7 offset:16928
    ds_read_b64_tr_b16 v[22:23], v7 offset:17184
    s_waitcnt lgkmcnt(0)
    v_mfma_f32_16x16x32_bf16 v[12:15], v[16:19], v[20:23], v[12:15]
    ds_write_b128 v6, v[72:75] offset:12800
    ds_write_b128 v6, v[76:79] offset:13824
    s_waitcnt lgkmcnt(0)
    ds_read_b128 v[16:19], v5 offset:20800
    ds_read_b64_tr_b16 v[20:21], v7 offset:12800
    ds_read_b64_tr_b16 v[22:23], v7 offset:13056
    s_waitcnt lgkmcnt(0)
    v_mfma_f32_16x16x32_bf16 v[8:11], v[16:19], v[20:23], v[8:11]
    ds_read_b64_tr_b16 v[20:21], v7 offset:12832
    ds_read_b64_tr_b16 v[22:23], v7 offset:13088
    s_waitcnt lgkmcnt(0)
    v_mfma_f32_16x16x32_bf16 v[12:15], v[16:19], v[20:23], v[12:15]
    s_nop 3
    v_max_f32 v8, 0, v8
    s_nop 2
    v_max_f32 v12, 0, v12
    v_mov_b32_dpp v9, v8 quad_perm:[1,0,3,2] row_mask:0xf bank_mask:0xf
    s_nop 0
    v_mov_b32_dpp v13, v12 quad_perm:[1,0,3,2] row_mask:0xf bank_mask:0xf
    v_cvt_pk_bf16_f32 v8, v8, v9
    v_cvt_pk_bf16_f32 v12, v12, v13
    v_readlane_b32 s76, v8, 0
    v_readlane_b32 s77, v8, 2
    v_readlane_b32 s78, v8, 4
    v_readlane_b32 s79, v8, 6
    v_readlane_b32 s80, v8, 8
    v_readlane_b32 s81, v8, 10
    v_readlane_b32 s82, v8, 12
    v_readlane_b32 s83, v8, 14
    v_readlane_b32 s84, v12, 0
    v_readlane_b32 s85, v12, 2
    v_readlane_b32 s86, v12, 4
    v_readlane_b32 s87, v12, 6
    v_readlane_b32 s88, v12, 8
    v_readlane_b32 s89, v12, 10
    v_mov_b32 v16, 0
    v_mov_b32 v17, 0
    v_mov_b32 v18, 0
    v_mov_b32 v19, 0
    v_mov_b32 v20, 0
    v_mov_b32 v21, 0
    v_mov_b32 v22, 0
    v_mov_b32 v23, 0
    s_waitcnt vmcnt(0)
    v_perm_b32 v24, v84, v80, s56
    v_perm_b32 v25, v84, v80, s57
    v_perm_b32 v26, v85, v81, s56
    v_perm_b32 v27, v85, v81, s57
    v_perm_b32 v28, v86, v82, s56
    v_perm_b32 v29, v86, v82, s57
    v_perm_b32 v30, v87, v83, s56
    v_perm_b32 v31, v87, v83, s57
    v_dot2_f32_bf16 v16, v24, s76, v16
    v_dot2_f32_bf16 v17, v25, s76, v17
    v_dot2_f32_bf16 v18, v26, s76, v18
    v_dot2_f32_bf16 v19, v27, s76, v19
    v_dot2_f32_bf16 v20, v28, s76, v20
    v_dot2_f32_bf16 v21, v29, s76, v21
    v_dot2_f32_bf16 v22, v30, s76, v22
    v_dot2_f32_bf16 v23, v31, s76, v23
    v_perm_b32 v24, v92, v88, s56
    v_perm_b32 v25, v92, v88, s57
    v_perm_b32 v26, v93, v89, s56
    v_perm_b32 v27, v93, v89, s57
    v_perm_b32 v28, v94, v90, s56
    v_perm_b32 v29, v94, v90, s57
    v_perm_b32 v30, v95, v91, s56
    v_perm_b32 v31, v95, v91, s57
    v_dot2_f32_bf16 v16, v24, s77, v16
    v_dot2_f32_bf16 v17, v25, s77, v17
    v_dot2_f32_bf16 v18, v26, s77, v18
    v_dot2_f32_bf16 v19, v27, s77, v19
    v_dot2_f32_bf16 v20, v28, s77, v20
    v_dot2_f32_bf16 v21, v29, s77, v21
    v_dot2_f32_bf16 v22, v30, s77, v22
    v_dot2_f32_bf16 v23, v31, s77, v23
    v_perm_b32 v24, v100, v96, s56
    v_perm_b32 v25, v100, v96, s57
    v_perm_b32 v26, v101, v97, s56
    v_perm_b32 v27, v101, v97, s57
    v_perm_b32 v28, v102, v98, s56
    v_perm_b32 v29, v102, v98, s57
    v_perm_b32 v30, v103, v99, s56
    v_perm_b32 v31, v103, v99, s57
    v_dot2_f32_bf16 v16, v24, s78, v16
    v_dot2_f32_bf16 v17, v25, s78, v17
    v_dot2_f32_bf16 v18, v26, s78, v18
    v_dot2_f32_bf16 v19, v27, s78, v19
    v_dot2_f32_bf16 v20, v28, s78, v20
    v_dot2_f32_bf16 v21, v29, s78, v21
    v_dot2_f32_bf16 v22, v30, s78, v22
    v_dot2_f32_bf16 v23, v31, s78, v23
    v_perm_b32 v24, v108, v104, s56
    v_perm_b32 v25, v108, v104, s57
    v_perm_b32 v26, v109, v105, s56
    v_perm_b32 v27, v109, v105, s57
    v_perm_b32 v28, v110, v106, s56
    v_perm_b32 v29, v110, v106, s57
    v_perm_b32 v30, v111, v107, s56
    v_perm_b32 v31, v111, v107, s57
    v_dot2_f32_bf16 v16, v24, s79, v16
    v_dot2_f32_bf16 v17, v25, s79, v17
    v_dot2_f32_bf16 v18, v26, s79, v18
    v_dot2_f32_bf16 v19, v27, s79, v19
    v_dot2_f32_bf16 v20, v28, s79, v20
    v_dot2_f32_bf16 v21, v29, s79, v21
    v_dot2_f32_bf16 v22, v30, s79, v22
    v_dot2_f32_bf16 v23, v31, s79, v23
    v_perm_b32 v24, v116, v112, s56
    v_perm_b32 v25, v116, v112, s57
    v_perm_b32 v26, v117, v113, s56
    v_perm_b32 v27, v117, v113, s57
    v_perm_b32 v28, v118, v114, s56
    v_perm_b32 v29, v118, v114, s57
    v_perm_b32 v30, v119, v115, s56
    v_perm_b32 v31, v119, v115, s57
    v_dot2_f32_bf16 v16, v24, s80, v16
    v_dot2_f32_bf16 v17, v25, s80, v17
    v_dot2_f32_bf16 v18, v26, s80, v18
    v_dot2_f32_bf16 v19, v27, s80, v19
    v_dot2_f32_bf16 v20, v28, s80, v20
    v_dot2_f32_bf16 v21, v29, s80, v21
    v_dot2_f32_bf16 v22, v30, s80, v22
    v_dot2_f32_bf16 v23, v31, s80, v23
    v_perm_b32 v24, v124, v120, s56
    v_perm_b32 v25, v124, v120, s57
    v_perm_b32 v26, v125, v121, s56
    v_perm_b32 v27, v125, v121, s57
    v_perm_b32 v28, v126, v122, s56
    v_perm_b32 v29, v126, v122, s57
    v_perm_b32 v30, v127, v123, s56
    v_perm_b32 v31, v127, v123, s57
    v_dot2_f32_bf16 v16, v24, s81, v16
    v_dot2_f32_bf16 v17, v25, s81, v17
    v_dot2_f32_bf16 v18, v26, s81, v18
    v_dot2_f32_bf16 v19, v27, s81, v19
    v_dot2_f32_bf16 v20, v28, s81, v20
    v_dot2_f32_bf16 v21, v29, s81, v21
    v_dot2_f32_bf16 v22, v30, s81, v22
    v_dot2_f32_bf16 v23, v31, s81, v23
    v_perm_b32 v24, v132, v128, s56
    v_perm_b32 v25, v132, v128, s57
    v_perm_b32 v26, v133, v129, s56
    v_perm_b32 v27, v133, v129, s57
    v_perm_b32 v28, v134, v130, s56
    v_perm_b32 v29, v134, v130, s57
    v_perm_b32 v30, v135, v131, s56
    v_perm_b32 v31, v135, v131, s57
    v_dot2_f32_bf16 v16, v24, s82, v16
    v_dot2_f32_bf16 v17, v25, s82, v17
    v_dot2_f32_bf16 v18, v26, s82, v18
    v_dot2_f32_bf16 v19, v27, s82, v19
    v_dot2_f32_bf16 v20, v28, s82, v20
    v_dot2_f32_bf16 v21, v29, s82, v21
    v_dot2_f32_bf16 v22, v30, s82, v22
    v_dot2_f32_bf16 v23, v31, s82, v23
    v_perm_b32 v24, v140, v136, s56
    v_perm_b32 v25, v140, v136, s57
    v_perm_b32 v26, v141, v137, s56
    v_perm_b32 v27, v141, v137, s57
    v_perm_b32 v28, v142, v138, s56
    v_perm_b32 v29, v142, v138, s57
    v_perm_b32 v30, v143, v139, s56
    v_perm_b32 v31, v143, v139, s57
    v_dot2_f32_bf16 v16, v24, s83, v16
    v_dot2_f32_bf16 v17, v25, s83, v17
    v_dot2_f32_bf16 v18, v26, s83, v18
    v_dot2_f32_bf16 v19, v27, s83, v19
    v_dot2_f32_bf16 v20, v28, s83, v20
    v_dot2_f32_bf16 v21, v29, s83, v21
    v_dot2_f32_bf16 v22, v30, s83, v22
    v_dot2_f32_bf16 v23, v31, s83, v23
    v_perm_b32 v24, v148, v144, s56
    v_perm_b32 v25, v148, v144, s57
    v_perm_b32 v26, v149, v145, s56
    v_perm_b32 v27, v149, v145, s57
    v_perm_b32 v28, v150, v146, s56
    v_perm_b32 v29, v150, v146, s57
    v_perm_b32 v30, v151, v147, s56
    v_perm_b32 v31, v151, v147, s57
    v_dot2_f32_bf16 v16, v24, s84, v16
    v_dot2_f32_bf16 v17, v25, s84, v17
    v_dot2_f32_bf16 v18, v26, s84, v18
    v_dot2_f32_bf16 v19, v27, s84, v19
    v_dot2_f32_bf16 v20, v28, s84, v20
    v_dot2_f32_bf16 v21, v29, s84, v21
    v_dot2_f32_bf16 v22, v30, s84, v22
    v_dot2_f32_bf16 v23, v31, s84, v23
    v_perm_b32 v24, v156, v152, s56
    v_perm_b32 v25, v156, v152, s57
    v_perm_b32 v26, v157, v153, s56
    v_perm_b32 v27, v157, v153, s57
    v_perm_b32 v28, v158, v154, s56
    v_perm_b32 v29, v158, v154, s57
    v_perm_b32 v30, v159, v155, s56
    v_perm_b32 v31, v159, v155, s57
    v_dot2_f32_bf16 v16, v24, s85, v16
    v_dot2_f32_bf16 v17, v25, s85, v17
    v_dot2_f32_bf16 v18, v26, s85, v18
    v_dot2_f32_bf16 v19, v27, s85, v19
    v_dot2_f32_bf16 v20, v28, s85, v20
    v_dot2_f32_bf16 v21, v29, s85, v21
    v_dot2_f32_bf16 v22, v30, s85, v22
    v_dot2_f32_bf16 v23, v31, s85, v23
    v_perm_b32 v24, v164, v160, s56
    v_perm_b32 v25, v164, v160, s57
    v_perm_b32 v26, v165, v161, s56
    v_perm_b32 v27, v165, v161, s57
    v_perm_b32 v28, v166, v162, s56
    v_perm_b32 v29, v166, v162, s57
    v_perm_b32 v30, v167, v163, s56
    v_perm_b32 v31, v167, v163, s57
    v_dot2_f32_bf16 v16, v24, s86, v16
    v_dot2_f32_bf16 v17, v25, s86, v17
    v_dot2_f32_bf16 v18, v26, s86, v18
    v_dot2_f32_bf16 v19, v27, s86, v19
    v_dot2_f32_bf16 v20, v28, s86, v20
    v_dot2_f32_bf16 v21, v29, s86, v21
    v_dot2_f32_bf16 v22, v30, s86, v22
    v_dot2_f32_bf16 v23, v31, s86, v23
    v_perm_b32 v24, v172, v168, s56
    v_perm_b32 v25, v172, v168, s57
    v_perm_b32 v26, v173, v169, s56
    v_perm_b32 v27, v173, v169, s57
    v_perm_b32 v28, v174, v170, s56
    v_perm_b32 v29, v174, v170, s57
    v_perm_b32 v30, v175, v171, s56
    v_perm_b32 v31, v175, v171, s57
    v_dot2_f32_bf16 v16, v24, s87, v16
    v_dot2_f32_bf16 v17, v25, s87, v17
    v_dot2_f32_bf16 v18, v26, s87, v18
    v_dot2_f32_bf16 v19, v27, s87, v19
    v_dot2_f32_bf16 v20, v28, s87, v20
    v_dot2_f32_bf16 v21, v29, s87, v21
    v_dot2_f32_bf16 v22, v30, s87, v22
    v_dot2_f32_bf16 v23, v31, s87, v23
    v_perm_b32 v24, v180, v176, s56
    v_perm_b32 v25, v180, v176, s57
    v_perm_b32 v26, v181, v177, s56
    v_perm_b32 v27, v181, v177, s57
    v_perm_b32 v28, v182, v178, s56
    v_perm_b32 v29, v182, v178, s57
    v_perm_b32 v30, v183, v179, s56
    v_perm_b32 v31, v183, v179, s57
    v_dot2_f32_bf16 v16, v24, s88, v16
    v_dot2_f32_bf16 v17, v25, s88, v17
    v_dot2_f32_bf16 v18, v26, s88, v18
    v_dot2_f32_bf16 v19, v27, s88, v19
    v_dot2_f32_bf16 v20, v28, s88, v20
    v_dot2_f32_bf16 v21, v29, s88, v21
    v_dot2_f32_bf16 v22, v30, s88, v22
    v_dot2_f32_bf16 v23, v31, s88, v23
    v_perm_b32 v24, v188, v184, s56
    v_perm_b32 v25, v188, v184, s57
    v_perm_b32 v26, v189, v185, s56
    v_perm_b32 v27, v189, v185, s57
    v_perm_b32 v28, v190, v186, s56
    v_perm_b32 v29, v190, v186, s57
    v_perm_b32 v30, v191, v187, s56
    v_perm_b32 v31, v191, v187, s57
    v_dot2_f32_bf16 v16, v24, s89, v16
    v_dot2_f32_bf16 v17, v25, s89, v17
    v_dot2_f32_bf16 v18, v26, s89, v18
    v_dot2_f32_bf16 v19, v27, s89, v19
    v_dot2_f32_bf16 v20, v28, s89, v20
    v_dot2_f32_bf16 v21, v29, s89, v21
    v_dot2_f32_bf16 v22, v30, s89, v22
    v_dot2_f32_bf16 v23, v31, s89, v23
    v_max_u32 v16, 1, v16
    v_max_u32 v17, 1, v17
    v_max_u32 v18, 1, v18
    v_max_u32 v19, 1, v19
    v_max_u32 v20, 1, v20
    v_max_u32 v21, 1, v21
    v_max_u32 v22, 1, v22
    v_max_u32 v23, 1, v23
    v_lshlrev_b32 v6, 5, v0
    ds_write_b128 v6, v[16:19] offset:2560
    ds_write_b128 v6, v[20:23] offset:2576
    v_mov_b32 v9, 0
    s_lshl_b32 s73, s2, 7
    s_add_u32 s73, s73, 0x40000
    s_mov_b32 s74, 0
    s_setprio 3
L_gpoll:
    buffer_load_dword v11, v9, s[44:47], s73 offen offset:4 sc1
    s_add_u32 s74, s74, 1
    s_waitcnt vmcnt(0)
    v_readfirstlane_b32 s75, v11
    s_cmp_ge_u32 s74, 1048576
    s_nop 3
    s_cbranch_scc1 L_ggot
    s_cmp_lg_u32 s75, 0
    s_cbranch_scc1 L_ggot
    s_sleep 8
    s_branch L_gpoll
L_ggot:
L_noffn:
    s_cmp_lg_u32 s34, 3
    s_cbranch_scc1 L_nogate
    s_mov_b32 s48, s20
    s_mov_b32 s49, s21
    s_mov_b32 s50, 0x380
    s_mov_b32 s51, 0x20000
    v_lshlrev_b32 v6, 1, v0
    s_mul_i32 s73, s32, 896
    buffer_load_ushort v16, v6, s[36:39], s73 offen offset:0
    buffer_load_ushort v24, v6, s[48:51], 0 offen offset:0
    buffer_load_ushort v17, v6, s[36:39], s73 offen offset:128
    buffer_load_ushort v25, v6, s[48:51], 0 offen offset:128
    buffer_load_ushort v18, v6, s[36:39], s73 offen offset:256
    buffer_load_ushort v26, v6, s[48:51], 0 offen offset:256
    buffer_load_ushort v19, v6, s[36:39], s73 offen offset:384
    buffer_load_ushort v27, v6, s[48:51], 0 offen offset:384
    buffer_load_ushort v20, v6, s[36:39], s73 offen offset:512
    buffer_load_ushort v28, v6, s[48:51], 0 offen offset:512
    buffer_load_ushort v21, v6, s[36:39], s73 offen offset:640
    buffer_load_ushort v29, v6, s[48:51], 0 offen offset:640
    buffer_load_ushort v22, v6, s[36:39], s73 offen offset:768
    buffer_load_ushort v30, v6, s[48:51], 0 offen offset:768
    v_mov_b32 v8, 0
    s_setprio 0
    s_waitcnt vmcnt(0)
    v_lshlrev_b32 v16, 16, v16
    v_lshlrev_b32 v24, 16, v24
    v_mul_f32 v16, v16, v24
    v_cvt_pk_bf16_f32 v16, v16, v16
    v_lshlrev_b32 v16, 16, v16
    v_add_f32 v8, v8, v16
    v_lshlrev_b32 v17, 16, v17
    v_lshlrev_b32 v25, 16, v25
    v_mul_f32 v17, v17, v25
    v_cvt_pk_bf16_f32 v17, v17, v17
    v_lshlrev_b32 v17, 16, v17
    v_add_f32 v8, v8, v17
    v_lshlrev_b32 v18, 16, v18
    v_lshlrev_b32 v26, 16, v26
    v_mul_f32 v18, v18, v26
    v_cvt_pk_bf16_f32 v18, v18, v18
    v_lshlrev_b32 v18, 16, v18
    v_add_f32 v8, v8, v18
    v_lshlrev_b32 v19, 16, v19
    v_lshlrev_b32 v27, 16, v27
    v_mul_f32 v19, v19, v27
    v_cvt_pk_bf16_f32 v19, v19, v19
    v_lshlrev_b32 v19, 16, v19
    v_add_f32 v8, v8, v19
    v_lshlrev_b32 v20, 16, v20
    v_lshlrev_b32 v28, 16, v28
    v_mul_f32 v20, v20, v28
    v_cvt_pk_bf16_f32 v20, v20, v20
    v_lshlrev_b32 v20, 16, v20
    v_add_f32 v8, v8, v20
    v_lshlrev_b32 v21, 16, v21
    v_lshlrev_b32 v29, 16, v29
    v_mul_f32 v21, v21, v29
    v_cvt_pk_bf16_f32 v21, v21, v21
    v_lshlrev_b32 v21, 16, v21
    v_add_f32 v8, v8, v21
    v_lshlrev_b32 v22, 16, v22
    v_lshlrev_b32 v30, 16, v30
    v_mul_f32 v22, v22, v30
    v_cvt_pk_bf16_f32 v22, v22, v22
    v_lshlrev_b32 v22, 16, v22
    v_add_f32 v8, v8, v22
    s_nop 1
    v_add_f32_dpp v8, v8, v8 quad_perm:[1,0,3,2] row_mask:0xf bank_mask:0xf
    s_nop 1
    v_add_f32_dpp v8, v8, v8 quad_perm:[2,3,0,1] row_mask:0xf bank_mask:0xf
    s_nop 1
    v_add_f32_dpp v8, v8, v8 row_half_mirror row_mask:0xf bank_mask:0xf
    s_nop 1
    v_add_f32_dpp v8, v8, v8 row_ror:8 row_mask:0xf bank_mask:0xf
    v_mov_b32 v9, v8
    s_nop 1
    v_permlane16_swap_b32 v8, v9
    v_add_f32 v8, v8, v9
    v_mov_b32 v9, v8
    s_nop 1
    v_permlane32_swap_b32 v8, v9
    v_add_f32 v8, v8, v9
    v_cvt_pk_bf16_f32 v8, v8, v8
    v_lshlrev_b32 v8, 16, v8
    v_mul_f32 v8, 0xbfb8aa3b, v8
    v_exp_f32 v8, v8
    s_nop 0
    v_add_f32 v8, 1.0, v8
    v_rcp_f32 v8, v8
    s_nop 0
    v_cvt_pk_bf16_f32 v8, v8, v8
    v_lshlrev_b32 v8, 16, v8
    v_sub_f32 v9, 1.0, v8
    v_cvt_pk_bf16_f32 v9, v9, v9
    v_lshlrev_b32 v9, 16, v9
    v_mov_b32 v6, 0
    s_mov_b64 exec, 1
    ds_write_b64 v6, v[8:9] offset:2176
    s_mov_b64 exec, -1
    s_setprio 3
L_nogate:
    s_mov_b32 s48, s12
    s_mov_b32 s49, s13
    s_mov_b32 s50, 0x380000
    s_mov_b32 s51, 0x20000
    s_lshl_b32 s73, s34, 8
    v_lshlrev_b32 v6, 2, v0
    v_add_u32 v6, s73, v6
    s_lshl_b32 s73, s31, 9
    s_lshl_b32 s74, s30, 6
    s_add_u32 s73, s73, s74
    s_mul_i32 s75, s73, 896
    buffer_load_dword v128, v6, s[48:51], s75 offen offset:0
    buffer_load_dword v129, v6, s[48:51], s75 offen offset:896
    buffer_load_dword v130, v6, s[48:51], s75 offen offset:1792
    buffer_load_dword v131, v6, s[48:51], s75 offen offset:2688
    s_add_u32 s75, s75, 3584
    buffer_load_dword v132, v6, s[48:51], s75 offen offset:0
    buffer_load_dword v133, v6, s[48:51], s75 offen offset:896
    buffer_load_dword v134, v6, s[48:51], s75 offen offset:1792
    buffer_load_dword v135, v6, s[48:51], s75 offen offset:2688
    s_add_u32 s75, s75, 3584
    buffer_load_dword v136, v6, s[48:51], s75 offen offset:0
    buffer_load_dword v137, v6, s[48:51], s75 offen offset:896
    buffer_load_dword v138, v6, s[48:51], s75 offen offset:1792
    buffer_load_dword v139, v6, s[48:51], s75 offen offset:2688
    s_add_u32 s75, s75, 3584
    buffer_load_dword v140, v6, s[48:51], s75 offen offset:0
    buffer_load_dword v141, v6, s[48:51], s75 offen offset:896
    buffer_load_dword v142, v6, s[48:51], s75 offen offset:1792
    buffer_load_dword v143, v6, s[48:51], s75 offen offset:2688
    s_add_u32 s75, s75, 3584
    buffer_load_dword v144, v6, s[48:51], s75 offen offset:0
    buffer_load_dword v145, v6, s[48:51], s75 offen offset:896
    buffer_load_dword v146, v6, s[48:51], s75 offen offset:1792
    buffer_load_dword v147, v6, s[48:51], s75 offen offset:2688
    s_add_u32 s75, s75, 3584
    buffer_load_dword v148, v6, s[48:51], s75 offen offset:0
    buffer_load_dword v149, v6, s[48:51], s75 offen offset:896
    buffer_load_dword v150, v6, s[48:51], s75 offen offset:1792
    buffer_load_dword v151, v6, s[48:51], s75 offen offset:2688
    s_add_u32 s75, s75, 3584
    buffer_load_dword v152, v6, s[48:51], s75 offen offset:0
    buffer_load_dword v153, v6, s[48:51], s75 offen offset:896
    buffer_load_dword v154, v6, s[48:51], s75 offen offset:1792
    buffer_load_dword v155, v6, s[48:51], s75 offen offset:2688
    s_add_u32 s75, s75, 3584
    buffer_load_dword v156, v6, s[48:51], s75 offen offset:0
    buffer_load_dword v157, v6, s[48:51], s75 offen offset:896
    buffer_load_dword v158, v6, s[48:51], s75 offen offset:1792
    buffer_load_dword v159, v6, s[48:51], s75 offen offset:2688
    s_add_u32 s75, s75, 3584
    buffer_load_dword v160, v6, s[48:51], s75 offen offset:0
    buffer_load_dword v161, v6, s[48:51], s75 offen offset:896
    buffer_load_dword v162, v6, s[48:51], s75 offen offset:1792
    buffer_load_dword v163, v6, s[48:51], s75 offen offset:2688
    s_add_u32 s75, s75, 3584
    buffer_load_dword v164, v6, s[48:51], s75 offen offset:0
    buffer_load_dword v165, v6, s[48:51], s75 offen offset:896
    buffer_load_dword v166, v6, s[48:51], s75 offen offset:1792
    buffer_load_dword v167, v6, s[48:51], s75 offen offset:2688
    s_add_u32 s75, s75, 3584
    buffer_load_dword v168, v6, s[48:51], s75 offen offset:0
    buffer_load_dword v169, v6, s[48:51], s75 offen offset:896
    buffer_load_dword v170, v6, s[48:51], s75 offen offset:1792
    buffer_load_dword v171, v6, s[48:51], s75 offen offset:2688
    s_add_u32 s75, s75, 3584
    buffer_load_dword v172, v6, s[48:51], s75 offen offset:0
    buffer_load_dword v173, v6, s[48:51], s75 offen offset:896
    buffer_load_dword v174, v6, s[48:51], s75 offen offset:1792
    buffer_load_dword v175, v6, s[48:51], s75 offen offset:2688
    s_add_u32 s75, s75, 3584
    buffer_load_dword v176, v6, s[48:51], s75 offen offset:0
    buffer_load_dword v177, v6, s[48:51], s75 offen offset:896
    buffer_load_dword v178, v6, s[48:51], s75 offen offset:1792
    buffer_load_dword v179, v6, s[48:51], s75 offen offset:2688
    s_add_u32 s75, s75, 3584
    buffer_load_dword v180, v6, s[48:51], s75 offen offset:0
    buffer_load_dword v181, v6, s[48:51], s75 offen offset:896
    buffer_load_dword v182, v6, s[48:51], s75 offen offset:1792
    buffer_load_dword v183, v6, s[48:51], s75 offen offset:2688
    s_add_u32 s75, s75, 3584
    buffer_load_dword v184, v6, s[48:51], s75 offen offset:0
    buffer_load_dword v185, v6, s[48:51], s75 offen offset:896
    buffer_load_dword v186, v6, s[48:51], s75 offen offset:1792
    buffer_load_dword v187, v6, s[48:51], s75 offen offset:2688
    s_waitcnt vmcnt(40)
    s_add_u32 s75, s75, 3584
    buffer_load_dword v188, v6, s[48:51], s75 offen offset:0
    buffer_load_dword v189, v6, s[48:51], s75 offen offset:896
    buffer_load_dword v190, v6, s[48:51], s75 offen offset:1792
    buffer_load_dword v191, v6, s[48:51], s75 offen offset:2688
    s_setprio 0
    s_waitcnt vmcnt(0)
    v_perm_b32 v7, v129, v128, s56
    v_perm_b32 v129, v129, v128, s57
    v_mov_b32 v128, v7
    v_perm_b32 v7, v131, v130, s56
    v_perm_b32 v131, v131, v130, s57
    v_mov_b32 v130, v7
    v_perm_b32 v7, v133, v132, s56
    v_perm_b32 v133, v133, v132, s57
    v_mov_b32 v132, v7
    v_perm_b32 v7, v135, v134, s56
    v_perm_b32 v135, v135, v134, s57
    v_mov_b32 v134, v7
    v_perm_b32 v7, v137, v136, s56
    v_perm_b32 v137, v137, v136, s57
    v_mov_b32 v136, v7
    v_perm_b32 v7, v139, v138, s56
    v_perm_b32 v139, v139, v138, s57
    v_mov_b32 v138, v7
    v_perm_b32 v7, v141, v140, s56
    v_perm_b32 v141, v141, v140, s57
    v_mov_b32 v140, v7
    v_perm_b32 v7, v143, v142, s56
    v_perm_b32 v143, v143, v142, s57
    v_mov_b32 v142, v7
    v_perm_b32 v7, v145, v144, s56
    v_perm_b32 v145, v145, v144, s57
    v_mov_b32 v144, v7
    v_perm_b32 v7, v147, v146, s56
    v_perm_b32 v147, v147, v146, s57
    v_mov_b32 v146, v7
    v_perm_b32 v7, v149, v148, s56
    v_perm_b32 v149, v149, v148, s57
    v_mov_b32 v148, v7
    v_perm_b32 v7, v151, v150, s56
    v_perm_b32 v151, v151, v150, s57
    v_mov_b32 v150, v7
    v_perm_b32 v7, v153, v152, s56
    v_perm_b32 v153, v153, v152, s57
    v_mov_b32 v152, v7
    v_perm_b32 v7, v155, v154, s56
    v_perm_b32 v155, v155, v154, s57
    v_mov_b32 v154, v7
    v_perm_b32 v7, v157, v156, s56
    v_perm_b32 v157, v157, v156, s57
    v_mov_b32 v156, v7
    v_perm_b32 v7, v159, v158, s56
    v_perm_b32 v159, v159, v158, s57
    v_mov_b32 v158, v7
    v_perm_b32 v7, v161, v160, s56
    v_perm_b32 v161, v161, v160, s57
    v_mov_b32 v160, v7
    v_perm_b32 v7, v163, v162, s56
    v_perm_b32 v163, v163, v162, s57
    v_mov_b32 v162, v7
    v_perm_b32 v7, v165, v164, s56
    v_perm_b32 v165, v165, v164, s57
    v_mov_b32 v164, v7
    v_perm_b32 v7, v167, v166, s56
    v_perm_b32 v167, v167, v166, s57
    v_mov_b32 v166, v7
    v_perm_b32 v7, v169, v168, s56
    v_perm_b32 v169, v169, v168, s57
    v_mov_b32 v168, v7
    v_perm_b32 v7, v171, v170, s56
    v_perm_b32 v171, v171, v170, s57
    v_mov_b32 v170, v7
    v_perm_b32 v7, v173, v172, s56
    v_perm_b32 v173, v173, v172, s57
    v_mov_b32 v172, v7
    v_perm_b32 v7, v175, v174, s56
    v_perm_b32 v175, v175, v174, s57
    v_mov_b32 v174, v7
    v_perm_b32 v7, v177, v176, s56
    v_perm_b32 v177, v177, v176, s57
    v_mov_b32 v176, v7
    v_perm_b32 v7, v179, v178, s56
    v_perm_b32 v179, v179, v178, s57
    v_mov_b32 v178, v7
    v_perm_b32 v7, v181, v180, s56
    v_perm_b32 v181, v181, v180, s57
    v_mov_b32 v180, v7
    v_perm_b32 v7, v183, v182, s56
    v_perm_b32 v183, v183, v182, s57
    v_mov_b32 v182, v7
    v_perm_b32 v7, v185, v184, s56
    v_perm_b32 v185, v185, v184, s57
    v_mov_b32 v184, v7
    v_perm_b32 v7, v187, v186, s56
    v_perm_b32 v187, v187, v186, s57
    v_mov_b32 v186, v7
    v_perm_b32 v7, v189, v188, s56
    v_perm_b32 v189, v189, v188, s57
    v_mov_b32 v188, v7
    v_perm_b32 v7, v191, v190, s56
    v_perm_b32 v191, v191, v190, s57
    v_mov_b32 v190, v7
    s_nop 2
L_combine:
    s_lshr_b32 s73, s28, 2
    s_and_b32 s74, s28, 3
    v_bfe_u32 v56, v0, 1, 1
    v_lshlrev_b32 v56, 10, v56
    v_lshrrev_b32 v57, 3, v0
    v_lshl_add_u32 v56, v57, 5, v56
    v_bfe_u32 v57, v0, 2, 1
    v_lshl_add_u32 v56, v57, 4, v56
    v_and_b32 v57, 1, v0
    v_lshl_add_u32 v56, v57, 3, v56
    s_lshl_b32 s75, s73, 9
    s_and_b32 s76, s74, 1
    s_lshl_b32 s76, s76, 8
    s_add_u32 s75, s75, s76
    s_lshr_b32 s76, s74, 1
    s_lshl_b32 s76, s76, 2
    s_add_u32 s75, s75, s76
    v_add_u32 v58, s75, v56
    v_lshlrev_b32 v57, 2, v0
    s_lshl_b32 s76, s28, 16
    s_lshl_b32 s77, s29, 11
    s_add_u32 s76, s76, s77
    s_lshl_b32 s77, s30, 8
    s_add_u32 s76, s76, s77
    s_add_u32 s76, s76, 0x100000
    s_lshl_b32 s77, s28, 11
    s_lshl_b32 s78, s29, 6
    s_add_u32 s77, s77, s78
    s_lshl_b32 s78, s30, 3
    s_add_u32 s77, s77, s78
    s_add_u32 s77, s77, 0x180000
    s_lshl_b32 s78, s73, 3
    v_mov_b32 v59, s78
    v_mov_b32 v56, 0
    s_waitcnt lgkmcnt(0)
    s_barrier
    ds_read_b32 v48, v58 offset:4608
    ds_read_b32 v49, v58 offset:6656
    ds_read_b32 v50, v58 offset:8704
    ds_read_b32 v51, v58 offset:10752
    ds_read_b32 v40, v59 offset:2052
    ds_read_b32 v41, v59 offset:2068
    ds_read_b32 v42, v59 offset:2084
    ds_read_b32 v43, v59 offset:2100
    v_lshrrev_b32 v59, 1, v59
    ds_read_b32 v52, v59 offset:2216
    s_waitcnt lgkmcnt(5)
    v_add_f32 v48, v48, v49
    v_add_f32 v50, v50, v51
    v_add_f32 v54, v48, v50
    v_max_u32 v54, 1, v54
    buffer_store_dword v54, v57, s[44:47], s76 offen sc1
    s_waitcnt lgkmcnt(0)
    v_add_f32 v40, v40, v41
    v_add_f32 v42, v42, v43
    v_add_f32 v53, v40, v42
    v_max_u32 v52, 1, v52
    s_mov_b64 exec, 1
    buffer_store_dwordx2 v[52:53], v56, s[44:47], s77 offen sc1
    s_mov_b64 exec, -1
    s_cmp_ge_u32 s28, 4
    s_cbranch_scc1 L_hop1
    s_cmp_lg_u32 s28, 0
    s_cbranch_scc1 L_end
    s_cmp_ge_u32 s33, 56
    s_cbranch_scc1 L_end
    v_mov_b32 v1, 0
    ds_read_b64 v[2:3], v1 offset:2176
    v_lshlrev_b32 v4, 4, v0
    s_lshl_b32 s73, s32, 6
    s_add_u32 s73, s73, s33
    s_lshl_b32 s73, s73, 12
    s_add_u32 s75, s73, 0x200000
    s_mov_b32 s48, s22
    s_mov_b32 s49, s23
    s_mov_b32 s50, 0xe00
    s_mov_b32 s51, 0x20000
    s_mov_b32 s62, 0x0
    s_mov_b32 s63, 0xffffffff
    v_and_b32 v7, 3, v0
    v_lshlrev_b32 v7, 2, v7
    v_bfe_u32 v5, v0, 4, 1
    v_lshl_add_u32 v7, v5, 1, v7
    s_mul_i32 s76, s32, 896
    s_lshl_b32 s77, s33, 4
    s_add_u32 s76, s76, s77
    s_mov_b32 s64, 0xf000f
    s_mov_b32 s65, 0x0
    s_waitcnt lgkmcnt(0)
    v_cndmask_b32_e64 v2, v2, v3, s[62:63]
    s_mov_b32 s78, 0
    s_nop 1
L_lw21:
    ds_read_b32 v5, v1 offset:2192
    s_add_u32 s78, s78, 1
    s_waitcnt lgkmcnt(0)
    v_readfirstlane_b32 s79, v5
    s_cmp_ge_u32 s78, 8388608
    s_nop 3
    s_cbranch_scc1 L_lw21_d
    s_cmp_ge_u32 s79, 4
    s_cbranch_scc1 L_lw21_d
    s_sleep 1
    s_branch L_lw21
L_lw21_d:
    s_mov_b32 s78, 0
L_g2:
    buffer_load_dwordx4 v[8:11], v4, s[44:47], s75 offen offset:0 sc1
    buffer_load_dwordx4 v[12:15], v4, s[44:47], s75 offen offset:1024 sc1
    buffer_load_dwordx4 v[16:19], v4, s[44:47], s75 offen offset:2048 sc1
    buffer_load_dwordx4 v[20:23], v4, s[44:47], s75 offen offset:3072 sc1
    s_add_u32 s78, s78, 1
    s_waitcnt vmcnt(0)
    v_min3_u32 v5, v8, v9, v10
    v_min3_u32 v6, v11, v12, v13
    v_min3_u32 v5, v5, v14, v15
    v_min3_u32 v6, v6, v16, v17
    v_min3_u32 v5, v5, v18, v19
    v_min3_u32 v6, v6, v20, v21
    v_min3_u32 v5, v5, v22, v23
    v_min_u32 v5, v5, v6
    s_cmp_ge_u32 s78, 1048576
    s_nop 1
    s_cbranch_scc1 L_g2_got
    v_cmp_eq_u32 vcc, 0, v5
    s_nop 4
    s_cbranch_vccz L_g2_got
    s_bcnt1_i32_b64 s79, vcc
    s_cmp_gt_u32 s79, 32
    s_cbranch_scc0 L_g2
    s_sleep 12
    s_branch L_g2
L_g2_got:
    v_add_f32 v8, v8, v12
    v_add_f32 v16, v16, v20
    v_add_f32 v9, v9, v13
    v_add_f32 v17, v17, v21
    v_add_f32 v10, v10, v14
    v_add_f32 v18, v18, v22
    v_add_f32 v11, v11, v15
    v_add_f32 v19, v19, v23
    v_add_f32 v8, v8, v16
    v_add_f32 v9, v9, v17
    v_add_f32 v10, v10, v18
    v_add_f32 v11, v11, v19
    s_nop 0
    v_permlane32_swap_b32 v8, v10
    v_permlane32_swap_b32 v9, v11
    v_add_f32 v8, v8, v10
    v_add_f32 v9, v9, v11
    s_nop 1
    v_permlane16_swap_b32 v8, v9
    v_add_f32 v8, v8, v9
    s_nop 1
    v_add_f32_dpp v8, v8, v8 row_ror:8 row_mask:0xf bank_mask:0xf
    s_nop 1
    v_add_f32_dpp v8, v8, v8 row_ror:4 row_mask:0xf bank_mask:0xf
    v_cvt_pk_bf16_f32 v8, v8, v8
    v_lshlrev_b32 v8, 16, v8
    v_mul_f32 v8, v2, v8
    v_cvt_pk_bf16_f32 v8, v8, v8
    v_lshlrev_b32 v8, 16, v8
    v_mov_b32 v9, v8
    s_nop 1
    v_permlane32_swap_b32 v8, v9
    v_add_f32 v8, v8, v9
    v_cvt_pk_bf16_f32 v8, v8, v8
    s_mov_b64 exec, s[64:65]
    buffer_store_short v8, v7, s[48:51], s76 offen
    s_mov_b64 exec, -1
    s_branch L_end
L_hop1:
    v_lshlrev_b32 v4, 2, v0
    v_and_b32 v5, 7, v0
    v_lshlrev_b32 v5, 3, v5
    s_lshl_b32 s73, s2, 11
    s_add_u32 s73, s73, 0x100000
    s_lshl_b32 s74, s2, 6
    s_add_u32 s74, s74, 0x180000
    v_lshrrev_b32 v6, 2, v0
    v_lshlrev_b32 v6, 12, v6
    v_and_b32 v7, 3, v0
    v_lshl_add_u32 v6, v7, 4, v6
    s_lshl_b32 s76, s34, 9
    v_lshlrev_b32 v7, 3, v0
    v_add_u32 v7, s76, v7
    ds_read_b64 v[58:59], v7 offset:2560
    s_lshl_b32 s75, s32, 6
    s_lshl_b32 s76, s34, 4
    s_add_u32 s75, s75, s76
    s_lshl_b32 s75, s75, 12
    s_lshl_b32 s76, s33, 6
    s_add_u32 s75, s75, s76
    s_add_u32 s75, s75, 0x200000
    s_mov_b32 s76, -1
    s_cmp_eq_u32 s34, 3
    s_cselect_b32 s77, 0, -1
    s_mov_b32 s78, 0
    v_mov_b32 v22, 0
    v_mov_b32 v23, 1
    v_mov_b32 v56, 0
    v_mov_b32 v57, 0
    s_waitcnt lgkmcnt(0)
    s_cmp_lg_u32 s34, 0
    s_nop 0
    s_cbranch_scc1 L_owait
L_h1poll:
    buffer_load_dwordx2 v[8:9], v5, s[44:47], s74 offen sc1
    buffer_load_dword v10, v4, s[44:47], s73 offen offset:0 sc1
    buffer_load_dword v11, v4, s[44:47], s73 offen offset:256 sc1
    buffer_load_dword v12, v4, s[44:47], s73 offen offset:512 sc1
    buffer_load_dword v13, v4, s[44:47], s73 offen offset:768 sc1
    buffer_load_dword v14, v4, s[44:47], s73 offen offset:1024 sc1
    buffer_load_dword v15, v4, s[44:47], s73 offen offset:1280 sc1
    buffer_load_dword v16, v4, s[44:47], s73 offen offset:1536 sc1
    buffer_load_dword v17, v4, s[44:47], s73 offen offset:1792 sc1
    s_add_u32 s78, s78, 1
    s_waitcnt vmcnt(0)
    v_min3_u32 v18, v8, v9, v10
    v_min3_u32 v19, v11, v12, v13
    v_min3_u32 v18, v18, v14, v15
    v_min3_u32 v19, v19, v16, v17
    v_min_u32 v18, v18, v19
    s_cmp_ge_u32 s78, 1048576
    s_nop 1
    s_cbranch_scc1 L_h1got
    v_cmp_eq_u32 vcc, 0, v18
    s_nop 4
    s_cbranch_vccz L_h1got
    v_cmp_eq_u32 vcc, 0, v8
    s_nop 0
    s_and_b32 s79, vcc_lo, 0xff
    s_bcnt1_i32_b32 s79, s79
    s_cmp_gt_u32 s79, 1
    s_nop 0
    s_cbranch_scc0 L_h1poll
    s_sleep 12
    s_branch L_h1poll
L_h1got:
    v_max_f32_dpp v18, v8, v8 quad_perm:[1,0,3,2] row_mask:0xf bank_mask:0xf
    s_nop 1
    v_max_f32_dpp v18, v18, v18 quad_perm:[2,3,0,1] row_mask:0xf bank_mask:0xf
    s_nop 1
    v_max_f32_dpp v18, v18, v18 row_half_mirror row_mask:0xf bank_mask:0xf
    v_sub_f32 v8, v8, v18
    v_mul_f32 v8, s58, v8
    v_exp_f32 v8, v8
    s_nop 0
    v_mul_f32 v9, v9, v8
    s_nop 1
    v_add_f32_dpp v9, v9, v9 quad_perm:[1,0,3,2] row_mask:0xf bank_mask:0xf
    s_nop 1
    v_add_f32_dpp v9, v9, v9 quad_perm:[2,3,0,1] row_mask:0xf bank_mask:0xf
    s_nop 1
    v_add_f32_dpp v9, v9, v9 row_half_mirror row_mask:0xf bank_mask:0xf
    v_rcp_f32 v9, v9
    v_readlane_b32 s80, v8, 0
    v_readlane_b32 s81, v8, 1
    v_readlane_b32 s82, v8, 2
    v_readlane_b32 s83, v8, 3
    v_readlane_b32 s84, v8, 4
    v_readlane_b32 s85, v8, 5
    v_readlane_b32 s86, v8, 6
    v_readlane_b32 s87, v8, 7
    v_mul_f32 v18, s80, v10
    v_fma_f32 v18, v11, s81, v18
    v_fma_f32 v18, v12, s82, v18
    v_fma_f32 v18, v13, s83, v18
    v_fma_f32 v18, v14, s84, v18
    v_fma_f32 v18, v15, s85, v18
    v_fma_f32 v18, v16, s86, v18
    v_fma_f32 v18, v17, s87, v18
    v_mul_f32 v18, v18, v9
    s_nop 1
    v_mov_b32_dpp v19, v18 quad_perm:[1,0,3,2] row_mask:0xf bank_mask:0xf
    v_cvt_pk_bf16_f32 v18, v18, v19
    v_lshlrev_b32 v19, 1, v0
    s_mov_b32 s80, 0x55555555
    s_mov_b32 s81, 0x55555555
    s_mov_b64 exec, s[80:81]
    ds_write_b32 v19, v18 offset:2304
    s_mov_b64 exec, -1
    s_waitcnt lgkmcnt(0)
    ds_write_b32 v22, v23 offset:2196
    s_branch L_ogot
L_owait:
    s_mov_b32 s78, 0
L_lw22:
    ds_read_b32 v8, v22 offset:2196
    s_add_u32 s78, s78, 1
    s_waitcnt lgkmcnt(0)
    v_readfirstlane_b32 s79, v8
    s_cmp_ge_u32 s78, 8388608
    s_nop 3
    s_cbranch_scc1 L_lw22_d
    s_cmp_lg_u32 s79, 0
    s_cbranch_scc0 L_lw22
L_lw22_d:
L_ogot:
    ds_read_b128 v[24:27], v22 offset:2304
    ds_read_b128 v[28:31], v22 offset:2320
    ds_read_b128 v[32:35], v22 offset:2336
    ds_read_b128 v[36:39], v22 offset:2352
    ds_read_b128 v[40:43], v22 offset:2368
    ds_read_b128 v[44:47], v22 offset:2384
    ds_read_b128 v[48:51], v22 offset:2400
    ds_read_b128 v[52:55], v22 offset:2416
    s_waitcnt lgkmcnt(7)
    v_dot2_f32_bf16 v56, v128, v24, v56
    v_dot2_f32_bf16 v57, v129, v24, v57
    v_dot2_f32_bf16 v56, v130, v25, v56
    v_dot2_f32_bf16 v57, v131, v25, v57
    v_dot2_f32_bf16 v56, v132, v26, v56
    v_dot2_f32_bf16 v57, v133, v26, v57
    v_dot2_f32_bf16 v56, v134, v27, v56
    v_dot2_f32_bf16 v57, v135, v27, v57
    s_waitcnt lgkmcnt(6)
    v_dot2_f32_bf16 v56, v136, v28, v56
    v_dot2_f32_bf16 v57, v137, v28, v57
    v_dot2_f32_bf16 v56, v138, v29, v56
    v_dot2_f32_bf16 v57, v139, v29, v57
    v_dot2_f32_bf16 v56, v140, v30, v56
    v_dot2_f32_bf16 v57, v141, v30, v57
    v_dot2_f32_bf16 v56, v142, v31, v56
    v_dot2_f32_bf16 v57, v143, v31, v57
    s_waitcnt lgkmcnt(5)
    v_dot2_f32_bf16 v56, v144, v32, v56
    v_dot2_f32_bf16 v57, v145, v32, v57
    v_dot2_f32_bf16 v56, v146, v33, v56
    v_dot2_f32_bf16 v57, v147, v33, v57
    v_dot2_f32_bf16 v56, v148, v34, v56
    v_dot2_f32_bf16 v57, v149, v34, v57
    v_dot2_f32_bf16 v56, v150, v35, v56
    v_dot2_f32_bf16 v57, v151, v35, v57
    s_waitcnt lgkmcnt(4)
    v_dot2_f32_bf16 v56, v152, v36, v56
    v_dot2_f32_bf16 v57, v153, v36, v57
    v_dot2_f32_bf16 v56, v154, v37, v56
    v_dot2_f32_bf16 v57, v155, v37, v57
    v_dot2_f32_bf16 v56, v156, v38, v56
    v_dot2_f32_bf16 v57, v157, v38, v57
    v_dot2_f32_bf16 v56, v158, v39, v56
    v_dot2_f32_bf16 v57, v159, v39, v57
    s_waitcnt lgkmcnt(3)
    v_dot2_f32_bf16 v56, v160, v40, v56
    v_dot2_f32_bf16 v57, v161, v40, v57
    v_dot2_f32_bf16 v56, v162, v41, v56
    v_dot2_f32_bf16 v57, v163, v41, v57
    v_dot2_f32_bf16 v56, v164, v42, v56
    v_dot2_f32_bf16 v57, v165, v42, v57
    v_dot2_f32_bf16 v56, v166, v43, v56
    v_dot2_f32_bf16 v57, v167, v43, v57
    s_waitcnt lgkmcnt(2)
    v_dot2_f32_bf16 v56, v168, v44, v56
    v_dot2_f32_bf16 v57, v169, v44, v57
    v_dot2_f32_bf16 v56, v170, v45, v56
    v_dot2_f32_bf16 v57, v171, v45, v57
    v_dot2_f32_bf16 v56, v172, v46, v56
    v_dot2_f32_bf16 v57, v173, v46, v57
    v_dot2_f32_bf16 v56, v174, v47, v56
    v_dot2_f32_bf16 v57, v175, v47, v57
    s_waitcnt lgkmcnt(1)
    v_dot2_f32_bf16 v56, v176, v48, v56
    v_dot2_f32_bf16 v57, v177, v48, v57
    v_dot2_f32_bf16 v56, v178, v49, v56
    v_dot2_f32_bf16 v57, v179, v49, v57
    v_dot2_f32_bf16 v56, v180, v50, v56
    v_dot2_f32_bf16 v57, v181, v50, v57
    v_dot2_f32_bf16 v56, v182, v51, v56
    v_dot2_f32_bf16 v57, v183, v51, v57
    s_waitcnt lgkmcnt(0)
    v_dot2_f32_bf16 v56, v184, v52, v56
    v_dot2_f32_bf16 v57, v185, v52, v57
    v_dot2_f32_bf16 v56, v186, v53, v56
    v_dot2_f32_bf16 v57, v187, v53, v57
    v_dot2_f32_bf16 v56, v188, v54, v56
    v_dot2_f32_bf16 v57, v189, v54, v57
    v_dot2_f32_bf16 v56, v190, v55, v56
    v_dot2_f32_bf16 v57, v191, v55, v57
    s_nop 1
    v_max_u32 v56, 1, v56
    v_max_u32 v57, 1, v57
    s_mov_b64 exec, s[76:77]
    buffer_store_dwordx4 v[56:59], v6, s[44:47], s75 offen sc1
    s_mov_b64 exec, 1
    ds_add_u32 v22, v23 offset:2192
L_end:
    s_endpgm
.section .rodata,"a"
.p2align 6
.amdhsa_kernel gated_mix__gqa_block_cached__dense_activation_relu__decode_kernel
  .amdhsa_next_free_vgpr 256
  .amdhsa_next_free_sgpr 102
  .amdhsa_accum_offset 256
  .amdhsa_group_segment_fixed_size 0
  .amdhsa_kernarg_size 96
  .amdhsa_user_sgpr_count 2
  .amdhsa_user_sgpr_kernarg_segment_ptr 1
  .amdhsa_system_sgpr_workgroup_id_x 1
  .amdhsa_float_denorm_mode_32 3
.end_amdhsa_kernel
```
